```python
import torch

def _softmax(x, axis=-1):
    return torch.softmax(x, dim=axis)
def _gelu(x):
    return torch.nn.functional.gelu(x, approximate="tanh")
def _silu(x):
    return torch.nn.functional.silu(x)
def _sigmoid(x):
    return torch.sigmoid(x)
def _layernorm(x, axis=-1, eps=1e-5):
    m = x.mean(dim=axis, keepdim=True)
    v = x.var(dim=axis, keepdim=True, unbiased=False)
    return (x - m) / torch.sqrt(v + eps)
def _scatter_add(tgt, idx, src, axis=0):
    return tgt.clone().index_add_(axis, idx, src)
def _segment_sum(src, seg, n):
    out = torch.zeros((n,) + src.shape[1:], dtype=src.dtype)
    return out.index_add_(0, seg, src)
def _pad(x, pw):
    flat = tuple(v for pair in reversed(pw) for v in pair)
    return torch.nn.functional.pad(x, flat)

kernel_name = 'sequential_preLN__ssm_conv_s4d__glu_gated_swiglu__prompt'

def setup_inputs():

    _w = (lambda a: (lambda t: t.to(torch.bfloat16) if t.is_floating_point() else t)(torch.as_tensor(a)))
    def _A_setup():
        Bsz, L, D, N = 1, 2048, 640, 192
        return {
            "u": _w((lambda *s: torch.randn(*s, dtype=torch.bfloat16) * 0.05)(Bsz, L, D)),
            "log_A_real": _w((lambda *s: torch.randn(*s, dtype=torch.bfloat16) * 6.4)(D, N) * 0.5),
            "A_imag": _w((lambda *s: torch.randn(*s, dtype=torch.bfloat16) * 0.05)(D, N) * 3.14),
            "C_real": _w((lambda *s: torch.randn(*s, dtype=torch.bfloat16) * 0.05)(D, N) / N ** 0.5),
            "C_imag": _w((lambda *s: torch.randn(*s, dtype=torch.bfloat16) * 0.05)(D, N) / N ** 0.5),
            "log_dt": _w((lambda *s: torch.randn(*s, dtype=torch.bfloat16) * 0.05)(D) * 0.5 - 4.0),
            "D_skip": _w((lambda *s: torch.randn(*s, dtype=torch.bfloat16) * 0.05)(D)),
        }
    _A_in = _A_setup()

    def _B_setup():
        B, S, D, F = 1, 2048, 640, 1536
        return {
            "x": _w((lambda *s: torch.randn(*s, dtype=torch.bfloat16) * 0.05)(B, S, D)),
            "w1": _w((lambda *s: torch.randn(*s, dtype=torch.bfloat16) * 0.4)(D, F) * (2.0 / D) ** 0.5),
            "w3": _w((lambda *s: torch.randn(*s, dtype=torch.bfloat16) * 0.4)(D, F) * (2.0 / D) ** 0.5),
            "w2": _w((lambda *s: torch.randn(*s, dtype=torch.bfloat16) * 0.4)(F, D) * (2.0 / F) ** 0.5),
        }
    _B_in = _B_setup()

    return {
        "A_u": _A_in["u"],
        "A_log_A_real": _A_in["log_A_real"],
        "A_A_imag": _A_in["A_imag"],
        "A_C_real": _A_in["C_real"],
        "A_C_imag": _A_in["C_imag"],
        "A_log_dt": _A_in["log_dt"],
        "A_D_skip": _A_in["D_skip"],
        "B_x": _B_in["x"],
        "B_w1": _B_in["w1"],
        "B_w3": _B_in["w3"],
        "B_w2": _B_in["w2"],
    }

def reference(A_u, A_log_A_real, A_A_imag, A_C_real, A_C_imag, A_log_dt, A_D_skip, B_x, B_w1, B_w3, B_w2):
    def _A_ref(u, log_A_real, A_imag, C_real, C_imag, log_dt, D_skip):
        L = u.shape[1]
        dt = torch.exp(log_dt)
        A = -torch.exp(log_A_real) + 1j * A_imag
        C = (C_real + 1j * C_imag) * dt[:, None]
        pos = (lambda x, dt: x.to(dt))(torch.arange(L), log_dt.dtype)
        P = torch.exp((A * dt[:, None])[:, :, None] * pos[None, None, :])
        K = 2.0 * torch.einsum("dn,dnl->dl", C, P).real
        L2 = 2 * L
        u_t = (lambda x, *d: x.permute(*d))(u, 0, 2, 1)
        Kf = (lambda x, *a, **k: torch.fft.rfft(x.float(), *a, **k))(K, L2)
        Uf = (lambda x, *a, **k: torch.fft.rfft(x.float(), *a, **k))(u_t, L2)
        y = (lambda x, *a, **k: torch.fft.irfft(x, *a, **k).to(torch.bfloat16))(Uf * Kf[None, :, :], L2)[:, :, :L]
        y = (lambda x, *d: x.permute(*d))(y, 0, 2, 1)
        return y + u * D_skip[None, None, :]

    def _B_ref(x, w1, w3, w2):
        gate = torch.einsum("bsd,df->bsf", x, w1)
        up = torch.einsum("bsd,df->bsf", x, w3)
        h = _silu(gate) * up
        out = torch.einsum("bsf,fd->bsd", h, w2)
        return out

    x = A_u
    h = x + _A_ref(_layernorm(x, axis=-1), A_log_A_real, A_A_imag, A_C_real, A_C_imag, A_log_dt, A_D_skip)
    h2 = h + _B_ref(_layernorm(h, axis=-1), B_w1, B_w3, B_w2)
    return h2
```

```asm
; @launch grid=(256,1,1) block=(512,1,1) lds=163840
.amdgcn_target "amdgcn-amd-amdhsa--gfx950"
.text
.globl sequential_preLN__ssm_conv_s4d__glu_gated_swiglu__prompt_kernel
.p2align 8
.type sequential_preLN__ssm_conv_s4d__glu_gated_swiglu__prompt_kernel,@function
sequential_preLN__ssm_conv_s4d__glu_gated_swiglu__prompt_kernel:
    s_cmp_ge_u32 s2, 256
    s_cbranch_scc1 L_exit
    s_load_dwordx2 s[4:5], s[0:1], 104
    s_load_dwordx16 s[8:23], s[0:1], 0
    s_load_dwordx8 s[24:31], s[0:1], 64
    v_and_b32 v1, 63, v0
    v_lshrrev_b32 v2, 6, v0
    v_lshrrev_b32 v3, 4, v1
    v_and_b32 v4, 15, v1
    v_readfirstlane_b32 s6, v2
    s_waitcnt lgkmcnt(0)
    s_load_dword s3, s[4:5], 0
    s_and_b32 s7, s6, 3
    s_mov_b32 s92, s4
    s_mov_b32 s93, s5
    s_mov_b32 s94, 196608
    s_mov_b32 s95, 0x20000
    v_mov_b32 v5, 163824
    v_mov_b32 v6, 0
    v_mov_b32 v7, 0
    v_mov_b32 v8, 0
    v_mov_b32 v9, 0
    ds_write_b128 v5, v[6:9]
    s_cmp_ge_u32 s2, 160
    s_cbranch_scc1 L_aux
    s_lshl_b32 s52, s2, 2
    s_add_u32 s52, s52, s7
    s_mul_i32 s53, s6, 15504
    s_lshr_b32 s54, s6, 2
    s_mul_i32 s55, s52, 384
    s_lshl_b32 s56, s54, 7
    s_add_u32 s55, s55, s56
    v_lshlrev_b32 v5, 1, v1
    s_lshl_b32 s56, s52, 1
    v_mov_b32 v6, 0
    s_mov_b32 s48, s18
    s_mov_b32 s49, s19
    s_mov_b32 s50, 1280
    s_mov_b32 s51, 0x20000
    buffer_load_ushort v92, v6, s[48:51], s56 offen
    s_mov_b32 s32, s10
    s_mov_b32 s33, s11
    s_mov_b32 s34, 245760
    s_mov_b32 s35, 0x20000
    buffer_load_ushort v8, v5, s[32:35], s55 offen
    s_mov_b32 s36, s12
    s_mov_b32 s37, s13
    s_mov_b32 s38, 245760
    s_mov_b32 s39, 0x20000
    buffer_load_ushort v9, v5, s[36:39], s55 offen
    s_mov_b32 s40, s14
    s_mov_b32 s41, s15
    s_mov_b32 s42, 245760
    s_mov_b32 s43, 0x20000
    buffer_load_ushort v10, v5, s[40:43], s55 offen
    s_mov_b32 s44, s16
    s_mov_b32 s45, s17
    s_mov_b32 s46, 245760
    s_mov_b32 s47, 0x20000
    buffer_load_ushort v11, v5, s[44:47], s55 offen
    buffer_load_ushort v96, v5, s[32:35], s55 offen offset:256
    buffer_load_ushort v97, v5, s[36:39], s55 offen offset:256
    buffer_load_ushort v98, v5, s[40:43], s55 offen offset:256
    buffer_load_ushort v99, v5, s[44:47], s55 offen offset:256
    s_mov_b32 s48, s20
    s_mov_b32 s49, s21
    s_mov_b32 s50, 1280
    s_mov_b32 s51, 0x20000
    buffer_load_ushort v240, v6, s[48:51], s56 offen
    v_lshlrev_b32 v6, 2, v1
    v_add_u32 v6, s53, v6
    v_mul_u32_u24 v7, 272, v4
    v_lshl_add_u32 v7, v3, 4, v7
    v_add_u32 v7, s53, v7
    v_mov_b32 v80, 0
    v_mov_b32 v81, 0
    v_mov_b32 v82, 0
    v_mov_b32 v83, 0
    v_mov_b32 v84, 0
    v_mov_b32 v85, 0
    v_mov_b32 v86, 0
    v_mov_b32 v87, 0
    v_mov_b32 v88, 0
    v_mov_b32 v89, 0
    v_mov_b32 v90, 0
    v_mov_b32 v91, 0
    s_cmp_ge_u32 s6, 4
    s_cbranch_scc1 L_kg_nopre
    s_mul_i32 s57, s7, 27776
    s_mul_i32 s62, s7, 4224
    s_add_u32 s62, s62, 126976
    s_mul_i32 s63, s7, 3072
    s_add_u32 s63, s63, 145408
    v_lshlrev_b32 v140, 4, v1
    v_add_u32 v125, s63, v140
    v_add_u32 v124, s57, v140
    v_lshlrev_b32 v141, 4, v4
    v_add_u32 v141, s62, v141
    v_lshrrev_b32 v142, 1, v3
    v_and_b32 v143, 1, v3
    v_cmp_gt_u32 vcc, 2, v3
    v_lshlrev_b32 v144, 8, v142
    v_lshl_add_u32 v144, v143, 3, v144
    v_add_u32 v100, v144, v141
    v_lshlrev_b32 v144, 8, v3
    v_add_u32 v144, 512, v144
    v_lshlrev_b32 v145, 9, v3
    v_cndmask_b32 v144, v145, v144, vcc
    v_add_u32 v101, v144, v141
    v_mov_b32 v144, 4
    v_mov_b32 v145, 8
    v_cndmask_b32 v144, v145, v144, vcc
    v_add_u32 v102, v101, v144
    v_mov_b32 v144, 8
    v_mov_b32 v145, 256
    v_cndmask_b32 v144, v145, v144, vcc
    v_add_u32 v103, v101, v144
    v_mov_b32 v144, 12
    v_mov_b32 v145, 264
    v_cndmask_b32 v144, v145, v144, vcc
    v_add_u32 v104, v101, v144
    v_lshlrev_b32 v144, 10, v3
    v_lshl_add_u32 v144, v4, 4, v144
    v_add_u32 v144, 2048, v144
    s_movk_i32 s63, 4112
    v_add_u32 v105, 0, v144
    v_min_u32 v105, s63, v105
    v_add_u32 v105, s62, v105
    v_add_u32 v106, 256, v144
    v_min_u32 v106, s63, v106
    v_add_u32 v106, s62, v106
    v_add_u32 v107, 512, v144
    v_min_u32 v107, s63, v107
    v_add_u32 v107, s62, v107
    v_add_u32 v108, 768, v144
    v_min_u32 v108, s63, v108
    v_add_u32 v108, s62, v108
    v_cmp_eq_u32 s[58:59], 63, v1
    v_mul_u32_u24 v144, 43691, v1
    v_lshrrev_b32 v144, 19, v144
    v_mul_u32_u24 v144, 1152, v144
    v_add_u32 v123, v144, v124
    v_add_u32 v144, 509, v3
    v_add_u32 v144, v144, v4
    v_add_u32 v145, 1015, v4
    v_cmp_lt_u32 vcc, 11, v4
    s_movk_i32 s63, 517
    v_cmp_ge_u32 s[60:61], s63, v144
    v_cndmask_b32 v144, v144, v145, vcc
    v_subrev_u32 v145, 12, v4
    v_cmp_gt_u32 s[82:83], 2, v145
    v_mov_b32 v145, 1208
    v_mov_b32 v146, 2104
    v_cndmask_b32 v145, v145, v146, vcc
    s_or_b64 s[60:61], s[60:61], s[82:83]
    v_mul_u32_u24 v146, 1346, v3
    v_add3_u32 v145, v145, v146, s57
    v_lshlrev_b32 v144, 1, v144
    v_sub_u32 v122, v145, v144
    v_cvt_f32_u32 v144, v144
    v_sub_u32 v145, 1022, v140
    v_cvt_f32_u32 v145, v145
    v_add_f32 v110, 0x80000000, v145
    v_add_f32 v111, 0xc0000000, v145
    v_cvt_pk_bf16_f32 v110, v110, v111
    v_and_b32 v111, 0xffff0000, v110
    v_lshlrev_b32 v110, 16, v110
    v_cvt_u32_f32 v110, v110
    v_cvt_u32_f32 v111, v111
    v_add_u32 v110, s62, v110
    v_add_u32 v111, s62, v111
    v_add_f32 v112, 0xc0800000, v145
    v_add_f32 v113, 0xc0c00000, v145
    v_cvt_pk_bf16_f32 v112, v112, v113
    v_and_b32 v113, 0xffff0000, v112
    v_lshlrev_b32 v112, 16, v112
    v_cvt_u32_f32 v112, v112
    v_cvt_u32_f32 v113, v113
    v_add_u32 v112, s62, v112
    v_add_u32 v113, s62, v113
    v_add_f32 v114, 0xc1000000, v145
    v_add_f32 v115, 0xc1200000, v145
    v_cvt_pk_bf16_f32 v114, v114, v115
    v_and_b32 v115, 0xffff0000, v114
    v_lshlrev_b32 v114, 16, v114
    v_cvt_u32_f32 v114, v114
    v_cvt_u32_f32 v115, v115
    v_add_u32 v114, s62, v114
    v_add_u32 v115, s62, v115
    v_add_f32 v116, 0xc1400000, v145
    v_add_f32 v117, 0xc1600000, v145
    v_cvt_pk_bf16_f32 v116, v116, v117
    v_and_b32 v117, 0xffff0000, v116
    v_lshlrev_b32 v116, 16, v116
    v_cvt_u32_f32 v116, v116
    v_cvt_u32_f32 v117, v117
    v_add_u32 v116, s62, v116
    v_add_u32 v117, s62, v117
    v_add_f32 v118, 0xc1800000, v145
    v_add_f32 v119, 0xc1900000, v145
    v_cvt_pk_bf16_f32 v118, v118, v119
    v_and_b32 v119, 0xffff0000, v118
    v_lshlrev_b32 v118, 16, v118
    v_cvt_u32_f32 v118, v118
    v_cvt_u32_f32 v119, v119
    v_add_u32 v118, s62, v118
    v_add_u32 v119, s62, v119
    v_add_f32 v120, 0xc1a00000, v145
    v_mov_b32 v121, v144
    v_cvt_pk_bf16_f32 v120, v120, v121
    v_and_b32 v121, 0xffff0000, v120
    v_lshlrev_b32 v120, 16, v120
    v_cvt_u32_f32 v120, v120
    v_cvt_u32_f32 v121, v121
    v_add_u32 v120, s62, v120
    v_add_u32 v121, s62, v121
    v_cmp_gt_u32 vcc, 32, v1
    v_cmp_le_u32 s[82:83], 42, v1
    v_subrev_u32 v144, 32, v1
    v_lshrrev_b32 v146, 3, v1
    v_cndmask_b32 v145, 0, 1, s[82:83]
    v_cndmask_b32 v145, v145, v146, vcc
    v_mul_u32_u24 v146, 10, v145
    v_sub_u32 v144, v144, v146
    v_and_b32 v146, 7, v1
    v_cndmask_b32 v144, v144, v146, vcc
    v_mov_b32 v146, 127
    v_mov_b32 v147, 79
    v_cndmask_b32 v146, v146, v147, vcc
    v_lshlrev_b32 v147, 3, v144
    v_sub_u32 v146, v146, v147
    v_add_u32 v147, 1, v145
    v_lshlrev_b32 v148, 4, v147
    v_lshlrev_b32 v147, 3, v147
    v_cndmask_b32 v147, v148, v147, vcc
    v_lshl_add_u32 v147, v146, 5, v147
    v_add_u32 v147, s62, v147
    v_subrev_u32 v126, 320, v147
    v_cmp_gt_u32 s[82:83], 8, v1
    v_mov_b32 v147, 64
    v_cndmask_b32 v147, v147, 32, vcc
    v_cndmask_b32 v128, v147, 31, s[82:83]
    v_cndmask_b32 v147, v147, 33, s[82:83]
    v_sub_u32 v127, v146, v147
    v_mov_b32 v146, 160
    v_mov_b32 v147, 128
    v_cndmask_b32 v146, v146, v147, vcc
    v_mov_b32 v147, 7424
    v_mov_b32 v148, 5376
    v_cndmask_b32 v147, v147, v148, vcc
    v_mul_u32_u24 v148, v146, v145
    v_lshl_add_u32 v147, v148, 2, v147
    v_lshl_add_u32 v147, v144, 4, v147
    v_add_u32 v129, s57, v147
    v_add_u32 v130, v129, v146
    v_add_u32 v131, v130, v146
    v_add_u32 v132, v131, v146
    v_and_b32 v144, 3, v4
    v_lshrrev_b32 v145, 2, v4
    v_lshlrev_b32 v145, 3, v145
    v_lshlrev_b32 v146, 4, v3
    v_mul_u32_u24 v168, 1344, v144
    v_sub_u32 v168, v168, v145
    v_sub_u32 v168, v168, v146
    v_add_u32 v168, 72, v168
    v_add_u32 v168, s57, v168
    v_lshlrev_b32 v169, 5, v4
    v_sub_u32 v169, v169, v146
    v_add_u32 v169, 8752, v169
    v_add_u32 v169, s57, v169
    v_lshl_add_u32 v144, v142, 2, v144
    v_lshlrev_b32 v146, 3, v143
    v_sub_u32 v146, v146, v145
    v_add3_u32 v146, v146, 24, s57
    v_lshl_add_u32 v170, v144, 7, v146
    v_add_u32 v170, 5376, v170
    v_mul_u32_u24 v171, 160, v144
    v_add_u32 v171, v171, v146
    v_add_u32 v171, 7424, v171
    v_bfe_u32 v144, v1, 2, 2
    v_lshl_add_u32 v144, v143, 2, v144
    v_lshlrev_b32 v144, 5, v144
    v_and_b32 v145, 3, v1
    v_lshl_add_u32 v144, v145, 3, v144
    v_add_u32 v144, s57, v144
    v_mul_u32_u24 v172, 3096, v142
    v_add3_u32 v172, v172, v144, 8
    v_add_u32 v172, 17408, v172
    v_mul_u32_u24 v173, 2064, v142
    v_add3_u32 v173, v173, v144, 16
    v_add_u32 v173, 23616, v173
    v_lshlrev_b32 v144, 5, v4
    v_lshl_add_u32 v144, v3, 3, v144
    v_add_u32 v174, s57, v144
    v_mov_b32 v136, 0
    v_mov_b32 v137, 0
    v_mov_b32 v138, 0
    v_mov_b32 v139, 0
L_kg_nopre:
    s_waitcnt lgkmcnt(0)
    s_add_u32 s3, s3, 1
    s_waitcnt vmcnt(5)
    v_lshlrev_b32 v92, 16, v92
    v_mul_f32 v92, 0x3fb8aa3b, v92
    v_exp_f32 v92, v92
    s_nop 0
    v_cvt_pk_bf16_f32 v92, v92, v92
    v_lshlrev_b32 v92, 16, v92
L_kgen:
    v_lshlrev_b32 v8, 16, v8
    v_mul_f32 v16, 0x3fb8aa3b, v8
    v_exp_f32 v16, v16
    v_lshlrev_b32 v9, 16, v9
    v_lshlrev_b32 v10, 16, v10
    v_lshlrev_b32 v11, 16, v11
    v_cvt_pk_bf16_f32 v16, v16, v16
    v_lshlrev_b32 v16, 16, v16
    v_mul_f32 v17, v9, v92
    v_mul_f32 v16, v16, v92
    v_mul_f32 v17, 0x3e22f983, v17
    v_mul_f32 v16, 0xbfb8aa3b, v16
    v_rndne_f32 v24, v17
    v_mul_f32 v20, v10, v92
    v_mul_f32 v21, v11, v92
    v_sub_f32 v17, v17, v24
    v_mul_f32 v20, 2.0, v20
    v_mul_f32 v21, -2.0, v21
    v_mul_f32 v24, 1.0, v16
    v_mul_f32 v25, 1.0, v17
    v_exp_f32 v24, v24
    v_cos_f32 v32, v25
    v_sin_f32 v33, v25
    s_nop 0
    v_mul_f32 v32, v32, v24
    v_mul_f32 v33, v33, v24
    v_mul_f32 v26, 0x41000000, v16
    v_mul_f32 v27, 0x41000000, v17
    v_exp_f32 v26, v26
    v_cos_f32 v18, v27
    v_sin_f32 v19, v27
    s_nop 0
    v_mul_f32 v18, v18, v26
    v_mul_f32 v19, -v19, v26
    v_mul_f32 v28, 0x43000000, v16
    v_mul_f32 v29, 0x43000000, v17
    v_exp_f32 v28, v28
    v_cos_f32 v46, v29
    v_sin_f32 v47, v29
    s_nop 0
    v_mul_f32 v46, v46, v28
    v_mul_f32 v47, v47, v28
    v_cvt_pk_bf16_f32 v48, 1.0, 0
    ds_write_b32 v6, v48 offset:0
    v_cvt_pk_bf16_f32 v49, v32, v33
    ds_write_b32 v6, v49 offset:272
    v_cvt_pk_bf16_f32 v50, v20, v21
    ds_write_b32 v6, v50 offset:11152
    v_pk_mul_f32 v[24:25], v[32:33], v[32:33] op_sel_hi:[1,0]
    v_pk_fma_f32 v[34:35], v[32:33], v[32:33], v[24:25] op_sel:[1,1,0] op_sel_hi:[0,1,1] neg_lo:[1,0,0]
    v_cvt_pk_bf16_f32 v51, v46, v47
    ds_write_b32 v6, v51 offset:2176
    v_pk_mul_f32 v[24:25], v[34:35], v[32:33] op_sel_hi:[1,0]
    v_pk_fma_f32 v[36:37], v[34:35], v[32:33], v[24:25] op_sel:[1,1,0] op_sel_hi:[0,1,1] neg_lo:[1,0,0]
    v_pk_mul_f32 v[26:27], v[34:35], v[34:35] op_sel_hi:[1,0]
    v_pk_fma_f32 v[38:39], v[34:35], v[34:35], v[26:27] op_sel:[1,1,0] op_sel_hi:[0,1,1] neg_lo:[1,0,0]
    v_cvt_pk_bf16_f32 v48, v34, v35
    ds_write_b32 v6, v48 offset:544
    v_pk_mul_f32 v[24:25], v[38:39], v[32:33] op_sel_hi:[1,0]
    v_pk_fma_f32 v[40:41], v[38:39], v[32:33], v[24:25] op_sel:[1,1,0] op_sel_hi:[0,1,1] neg_lo:[1,0,0]
    v_pk_mul_f32 v[26:27], v[38:39], v[34:35] op_sel_hi:[1,0]
    v_pk_fma_f32 v[42:43], v[38:39], v[34:35], v[26:27] op_sel:[1,1,0] op_sel_hi:[0,1,1] neg_lo:[1,0,0]
    v_pk_mul_f32 v[28:29], v[38:39], v[36:37] op_sel_hi:[1,0]
    v_pk_fma_f32 v[44:45], v[38:39], v[36:37], v[28:29] op_sel:[1,1,0] op_sel_hi:[0,1,1] neg_lo:[1,0,0]
    v_cvt_pk_bf16_f32 v49, v36, v37
    ds_write_b32 v6, v49 offset:816
    v_cvt_pk_bf16_f32 v50, v38, v39
    ds_write_b32 v6, v50 offset:1088
    v_cvt_pk_bf16_f32 v51, v40, v41
    ds_write_b32 v6, v51 offset:1360
    v_cvt_pk_bf16_f32 v48, v42, v43
    ds_write_b32 v6, v48 offset:1632
    v_cvt_pk_bf16_f32 v49, v44, v45
    ds_write_b32 v6, v49 offset:1904
    v_pk_mul_f32 v[28:29], v[46:47], v[32:33] op_sel_hi:[1,0]
    v_pk_fma_f32 v[28:29], v[46:47], v[32:33], v[28:29] op_sel:[1,1,0] op_sel_hi:[0,1,1] neg_lo:[1,0,0]
    v_cvt_pk_bf16_f32 v50, v28, v29
    ds_write_b32 v6, v50 offset:2448
    v_pk_mul_f32 v[30:31], v[46:47], v[34:35] op_sel_hi:[1,0]
    v_pk_fma_f32 v[30:31], v[46:47], v[34:35], v[30:31] op_sel:[1,1,0] op_sel_hi:[0,1,1] neg_lo:[1,0,0]
    v_cvt_pk_bf16_f32 v51, v30, v31
    ds_write_b32 v6, v51 offset:2720
    v_pk_mul_f32 v[24:25], v[20:21], v[18:19] op_sel_hi:[1,0]
    v_pk_fma_f32 v[20:21], v[20:21], v[18:19], v[24:25] op_sel:[1,1,0] op_sel_hi:[0,1,1] neg_lo:[1,0,0]
    v_cvt_pk_bf16_f32 v48, v20, v21
    ds_write_b32 v6, v48 offset:11424
    v_pk_mul_f32 v[28:29], v[46:47], v[36:37] op_sel_hi:[1,0]
    v_pk_fma_f32 v[28:29], v[46:47], v[36:37], v[28:29] op_sel:[1,1,0] op_sel_hi:[0,1,1] neg_lo:[1,0,0]
    v_cvt_pk_bf16_f32 v49, v28, v29
    ds_write_b32 v6, v49 offset:2992
    v_pk_mul_f32 v[30:31], v[46:47], v[38:39] op_sel_hi:[1,0]
    v_pk_fma_f32 v[30:31], v[46:47], v[38:39], v[30:31] op_sel:[1,1,0] op_sel_hi:[0,1,1] neg_lo:[1,0,0]
    v_cvt_pk_bf16_f32 v50, v30, v31
    ds_write_b32 v6, v50 offset:3264
    v_pk_mul_f32 v[24:25], v[20:21], v[18:19] op_sel_hi:[1,0]
    v_pk_fma_f32 v[20:21], v[20:21], v[18:19], v[24:25] op_sel:[1,1,0] op_sel_hi:[0,1,1] neg_lo:[1,0,0]
    v_cvt_pk_bf16_f32 v51, v20, v21
    ds_write_b32 v6, v51 offset:11696
    v_pk_mul_f32 v[28:29], v[46:47], v[40:41] op_sel_hi:[1,0]
    v_pk_fma_f32 v[28:29], v[46:47], v[40:41], v[28:29] op_sel:[1,1,0] op_sel_hi:[0,1,1] neg_lo:[1,0,0]
    v_cvt_pk_bf16_f32 v48, v28, v29
    ds_write_b32 v6, v48 offset:3536
    v_pk_mul_f32 v[30:31], v[46:47], v[42:43] op_sel_hi:[1,0]
    v_pk_fma_f32 v[30:31], v[46:47], v[42:43], v[30:31] op_sel:[1,1,0] op_sel_hi:[0,1,1] neg_lo:[1,0,0]
    v_cvt_pk_bf16_f32 v49, v30, v31
    ds_write_b32 v6, v49 offset:3808
    v_pk_mul_f32 v[24:25], v[20:21], v[18:19] op_sel_hi:[1,0]
    v_pk_fma_f32 v[20:21], v[20:21], v[18:19], v[24:25] op_sel:[1,1,0] op_sel_hi:[0,1,1] neg_lo:[1,0,0]
    v_cvt_pk_bf16_f32 v50, v20, v21
    ds_write_b32 v6, v50 offset:11968
    v_pk_mul_f32 v[28:29], v[46:47], v[44:45] op_sel_hi:[1,0]
    v_pk_fma_f32 v[28:29], v[46:47], v[44:45], v[28:29] op_sel:[1,1,0] op_sel_hi:[0,1,1] neg_lo:[1,0,0]
    v_cvt_pk_bf16_f32 v51, v28, v29
    ds_write_b32 v6, v51 offset:4080
    v_pk_mul_f32 v[26:27], v[46:47], v[46:47] op_sel_hi:[1,0]
    v_pk_fma_f32 v[22:23], v[46:47], v[46:47], v[26:27] op_sel:[1,1,0] op_sel_hi:[0,1,1] neg_lo:[1,0,0]
    v_cvt_pk_bf16_f32 v48, v22, v23
    ds_write_b32 v6, v48 offset:4352
    v_pk_mul_f32 v[24:25], v[20:21], v[18:19] op_sel_hi:[1,0]
    v_pk_fma_f32 v[20:21], v[20:21], v[18:19], v[24:25] op_sel:[1,1,0] op_sel_hi:[0,1,1] neg_lo:[1,0,0]
    v_cvt_pk_bf16_f32 v49, v20, v21
    ds_write_b32 v6, v49 offset:12240
    v_pk_mul_f32 v[28:29], v[22:23], v[34:35] op_sel_hi:[1,0]
    v_pk_fma_f32 v[28:29], v[22:23], v[34:35], v[28:29] op_sel:[1,1,0] op_sel_hi:[0,1,1] neg_lo:[1,0,0]
    v_cvt_pk_bf16_f32 v50, v28, v29
    ds_write_b32 v6, v50 offset:4624
    v_pk_mul_f32 v[30:31], v[22:23], v[38:39] op_sel_hi:[1,0]
    v_pk_fma_f32 v[30:31], v[22:23], v[38:39], v[30:31] op_sel:[1,1,0] op_sel_hi:[0,1,1] neg_lo:[1,0,0]
    v_cvt_pk_bf16_f32 v51, v30, v31
    ds_write_b32 v6, v51 offset:4896
    v_pk_mul_f32 v[24:25], v[20:21], v[18:19] op_sel_hi:[1,0]
    v_pk_fma_f32 v[20:21], v[20:21], v[18:19], v[24:25] op_sel:[1,1,0] op_sel_hi:[0,1,1] neg_lo:[1,0,0]
    v_cvt_pk_bf16_f32 v48, v20, v21
    ds_write_b32 v6, v48 offset:12512
    v_pk_mul_f32 v[28:29], v[22:23], v[42:43] op_sel_hi:[1,0]
    v_pk_fma_f32 v[28:29], v[22:23], v[42:43], v[28:29] op_sel:[1,1,0] op_sel_hi:[0,1,1] neg_lo:[1,0,0]
    v_cvt_pk_bf16_f32 v49, v28, v29
    ds_write_b32 v6, v49 offset:5168
    v_pk_mul_f32 v[26:27], v[22:23], v[46:47] op_sel_hi:[1,0]
    v_pk_fma_f32 v[22:23], v[22:23], v[46:47], v[26:27] op_sel:[1,1,0] op_sel_hi:[0,1,1] neg_lo:[1,0,0]
    v_cvt_pk_bf16_f32 v50, v22, v23
    ds_write_b32 v6, v50 offset:5440
    v_pk_mul_f32 v[24:25], v[20:21], v[18:19] op_sel_hi:[1,0]
    v_pk_fma_f32 v[20:21], v[20:21], v[18:19], v[24:25] op_sel:[1,1,0] op_sel_hi:[0,1,1] neg_lo:[1,0,0]
    v_cvt_pk_bf16_f32 v51, v20, v21
    ds_write_b32 v6, v51 offset:12784
    v_pk_mul_f32 v[28:29], v[22:23], v[34:35] op_sel_hi:[1,0]
    v_pk_fma_f32 v[28:29], v[22:23], v[34:35], v[28:29] op_sel:[1,1,0] op_sel_hi:[0,1,1] neg_lo:[1,0,0]
    v_cvt_pk_bf16_f32 v48, v28, v29
    ds_write_b32 v6, v48 offset:5712
    v_pk_mul_f32 v[30:31], v[22:23], v[38:39] op_sel_hi:[1,0]
    v_pk_fma_f32 v[30:31], v[22:23], v[38:39], v[30:31] op_sel:[1,1,0] op_sel_hi:[0,1,1] neg_lo:[1,0,0]
    v_cvt_pk_bf16_f32 v49, v30, v31
    ds_write_b32 v6, v49 offset:5984
    v_pk_mul_f32 v[24:25], v[20:21], v[18:19] op_sel_hi:[1,0]
    v_pk_fma_f32 v[20:21], v[20:21], v[18:19], v[24:25] op_sel:[1,1,0] op_sel_hi:[0,1,1] neg_lo:[1,0,0]
    v_cvt_pk_bf16_f32 v50, v20, v21
    ds_write_b32 v6, v50 offset:13056
    v_pk_mul_f32 v[28:29], v[22:23], v[42:43] op_sel_hi:[1,0]
    v_pk_fma_f32 v[28:29], v[22:23], v[42:43], v[28:29] op_sel:[1,1,0] op_sel_hi:[0,1,1] neg_lo:[1,0,0]
    v_cvt_pk_bf16_f32 v51, v28, v29
    ds_write_b32 v6, v51 offset:6256
    v_pk_mul_f32 v[26:27], v[22:23], v[46:47] op_sel_hi:[1,0]
    v_pk_fma_f32 v[22:23], v[22:23], v[46:47], v[26:27] op_sel:[1,1,0] op_sel_hi:[0,1,1] neg_lo:[1,0,0]
    v_cvt_pk_bf16_f32 v48, v22, v23
    ds_write_b32 v6, v48 offset:6528
    v_pk_mul_f32 v[24:25], v[20:21], v[18:19] op_sel_hi:[1,0]
    v_pk_fma_f32 v[20:21], v[20:21], v[18:19], v[24:25] op_sel:[1,1,0] op_sel_hi:[0,1,1] neg_lo:[1,0,0]
    v_cvt_pk_bf16_f32 v49, v20, v21
    ds_write_b32 v6, v49 offset:13328
    v_pk_mul_f32 v[28:29], v[22:23], v[38:39] op_sel_hi:[1,0]
    v_pk_fma_f32 v[28:29], v[22:23], v[38:39], v[28:29] op_sel:[1,1,0] op_sel_hi:[0,1,1] neg_lo:[1,0,0]
    v_cvt_pk_bf16_f32 v50, v28, v29
    ds_write_b32 v6, v50 offset:6800
    v_pk_mul_f32 v[26:27], v[22:23], v[46:47] op_sel_hi:[1,0]
    v_pk_fma_f32 v[22:23], v[22:23], v[46:47], v[26:27] op_sel:[1,1,0] op_sel_hi:[0,1,1] neg_lo:[1,0,0]
    v_cvt_pk_bf16_f32 v51, v22, v23
    ds_write_b32 v6, v51 offset:7072
    v_pk_mul_f32 v[24:25], v[20:21], v[18:19] op_sel_hi:[1,0]
    v_pk_fma_f32 v[20:21], v[20:21], v[18:19], v[24:25] op_sel:[1,1,0] op_sel_hi:[0,1,1] neg_lo:[1,0,0]
    v_cvt_pk_bf16_f32 v48, v20, v21
    ds_write_b32 v6, v48 offset:13600
    v_pk_mul_f32 v[28:29], v[22:23], v[38:39] op_sel_hi:[1,0]
    v_pk_fma_f32 v[28:29], v[22:23], v[38:39], v[28:29] op_sel:[1,1,0] op_sel_hi:[0,1,1] neg_lo:[1,0,0]
    v_cvt_pk_bf16_f32 v49, v28, v29
    ds_write_b32 v6, v49 offset:7344
    v_pk_mul_f32 v[26:27], v[22:23], v[46:47] op_sel_hi:[1,0]
    v_pk_fma_f32 v[22:23], v[22:23], v[46:47], v[26:27] op_sel:[1,1,0] op_sel_hi:[0,1,1] neg_lo:[1,0,0]
    v_cvt_pk_bf16_f32 v50, v22, v23
    ds_write_b32 v6, v50 offset:7616
    v_pk_mul_f32 v[24:25], v[20:21], v[18:19] op_sel_hi:[1,0]
    v_pk_fma_f32 v[20:21], v[20:21], v[18:19], v[24:25] op_sel:[1,1,0] op_sel_hi:[0,1,1] neg_lo:[1,0,0]
    v_cvt_pk_bf16_f32 v51, v20, v21
    ds_write_b32 v6, v51 offset:13872
    v_pk_mul_f32 v[28:29], v[22:23], v[38:39] op_sel_hi:[1,0]
    v_pk_fma_f32 v[28:29], v[22:23], v[38:39], v[28:29] op_sel:[1,1,0] op_sel_hi:[0,1,1] neg_lo:[1,0,0]
    v_cvt_pk_bf16_f32 v48, v28, v29
    ds_write_b32 v6, v48 offset:7888
    v_pk_mul_f32 v[26:27], v[22:23], v[46:47] op_sel_hi:[1,0]
    v_pk_fma_f32 v[22:23], v[22:23], v[46:47], v[26:27] op_sel:[1,1,0] op_sel_hi:[0,1,1] neg_lo:[1,0,0]
    v_cvt_pk_bf16_f32 v49, v22, v23
    ds_write_b32 v6, v49 offset:8160
    v_pk_mul_f32 v[24:25], v[20:21], v[18:19] op_sel_hi:[1,0]
    v_pk_fma_f32 v[20:21], v[20:21], v[18:19], v[24:25] op_sel:[1,1,0] op_sel_hi:[0,1,1] neg_lo:[1,0,0]
    v_cvt_pk_bf16_f32 v50, v20, v21
    ds_write_b32 v6, v50 offset:14144
    v_pk_mul_f32 v[28:29], v[22:23], v[38:39] op_sel_hi:[1,0]
    v_pk_fma_f32 v[28:29], v[22:23], v[38:39], v[28:29] op_sel:[1,1,0] op_sel_hi:[0,1,1] neg_lo:[1,0,0]
    v_cvt_pk_bf16_f32 v51, v28, v29
    ds_write_b32 v6, v51 offset:8432
    v_pk_mul_f32 v[26:27], v[22:23], v[46:47] op_sel_hi:[1,0]
    v_pk_fma_f32 v[22:23], v[22:23], v[46:47], v[26:27] op_sel:[1,1,0] op_sel_hi:[0,1,1] neg_lo:[1,0,0]
    v_cvt_pk_bf16_f32 v48, v22, v23
    ds_write_b32 v6, v48 offset:8704
    v_pk_mul_f32 v[24:25], v[20:21], v[18:19] op_sel_hi:[1,0]
    v_pk_fma_f32 v[20:21], v[20:21], v[18:19], v[24:25] op_sel:[1,1,0] op_sel_hi:[0,1,1] neg_lo:[1,0,0]
    v_cvt_pk_bf16_f32 v49, v20, v21
    ds_write_b32 v6, v49 offset:14416
    v_pk_mul_f32 v[26:27], v[22:23], v[46:47] op_sel_hi:[1,0]
    v_pk_fma_f32 v[22:23], v[22:23], v[46:47], v[26:27] op_sel:[1,1,0] op_sel_hi:[0,1,1] neg_lo:[1,0,0]
    v_cvt_pk_bf16_f32 v50, v22, v23
    ds_write_b32 v6, v50 offset:8976
    v_pk_mul_f32 v[26:27], v[22:23], v[46:47] op_sel_hi:[1,0]
    v_pk_fma_f32 v[22:23], v[22:23], v[46:47], v[26:27] op_sel:[1,1,0] op_sel_hi:[0,1,1] neg_lo:[1,0,0]
    v_cvt_pk_bf16_f32 v51, v22, v23
    ds_write_b32 v6, v51 offset:9248
    v_pk_mul_f32 v[24:25], v[20:21], v[18:19] op_sel_hi:[1,0]
    v_pk_fma_f32 v[20:21], v[20:21], v[18:19], v[24:25] op_sel:[1,1,0] op_sel_hi:[0,1,1] neg_lo:[1,0,0]
    v_cvt_pk_bf16_f32 v48, v20, v21
    ds_write_b32 v6, v48 offset:14688
    v_pk_mul_f32 v[26:27], v[22:23], v[46:47] op_sel_hi:[1,0]
    v_pk_fma_f32 v[22:23], v[22:23], v[46:47], v[26:27] op_sel:[1,1,0] op_sel_hi:[0,1,1] neg_lo:[1,0,0]
    v_cvt_pk_bf16_f32 v49, v22, v23
    ds_write_b32 v6, v49 offset:9520
    v_pk_mul_f32 v[26:27], v[22:23], v[46:47] op_sel_hi:[1,0]
    v_pk_fma_f32 v[22:23], v[22:23], v[46:47], v[26:27] op_sel:[1,1,0] op_sel_hi:[0,1,1] neg_lo:[1,0,0]
    v_cvt_pk_bf16_f32 v50, v22, v23
    ds_write_b32 v6, v50 offset:9792
    v_pk_mul_f32 v[24:25], v[20:21], v[18:19] op_sel_hi:[1,0]
    v_pk_fma_f32 v[20:21], v[20:21], v[18:19], v[24:25] op_sel:[1,1,0] op_sel_hi:[0,1,1] neg_lo:[1,0,0]
    v_cvt_pk_bf16_f32 v51, v20, v21
    ds_write_b32 v6, v51 offset:14960
    v_pk_mul_f32 v[26:27], v[22:23], v[46:47] op_sel_hi:[1,0]
    v_pk_fma_f32 v[22:23], v[22:23], v[46:47], v[26:27] op_sel:[1,1,0] op_sel_hi:[0,1,1] neg_lo:[1,0,0]
    v_cvt_pk_bf16_f32 v48, v22, v23
    ds_write_b32 v6, v48 offset:10064
    v_pk_mul_f32 v[26:27], v[22:23], v[46:47] op_sel_hi:[1,0]
    v_pk_fma_f32 v[22:23], v[22:23], v[46:47], v[26:27] op_sel:[1,1,0] op_sel_hi:[0,1,1] neg_lo:[1,0,0]
    v_cvt_pk_bf16_f32 v49, v22, v23
    ds_write_b32 v6, v49 offset:10336
    v_pk_mul_f32 v[24:25], v[20:21], v[18:19] op_sel_hi:[1,0]
    v_pk_fma_f32 v[20:21], v[20:21], v[18:19], v[24:25] op_sel:[1,1,0] op_sel_hi:[0,1,1] neg_lo:[1,0,0]
    v_cvt_pk_bf16_f32 v50, v20, v21
    ds_write_b32 v6, v50 offset:15232
    v_pk_mul_f32 v[26:27], v[22:23], v[46:47] op_sel_hi:[1,0]
    v_pk_fma_f32 v[22:23], v[22:23], v[46:47], v[26:27] op_sel:[1,1,0] op_sel_hi:[0,1,1] neg_lo:[1,0,0]
    v_cvt_pk_bf16_f32 v51, v22, v23
    ds_write_b32 v6, v51 offset:10608
    v_pk_mul_f32 v[26:27], v[22:23], v[46:47] op_sel_hi:[1,0]
    v_pk_fma_f32 v[22:23], v[22:23], v[46:47], v[26:27] op_sel:[1,1,0] op_sel_hi:[0,1,1] neg_lo:[1,0,0]
    v_cvt_pk_bf16_f32 v48, v22, v23
    ds_write_b32 v6, v48 offset:10880
    s_waitcnt lgkmcnt(0)
    ds_read_b128 v[16:19], v7 offset:11152
    ds_read_b128 v[20:23], v7 offset:0
    ds_read_b128 v[24:27], v7 offset:4352
    ds_read_b128 v[28:31], v7 offset:8704
    ds_read_b128 v[32:35], v7 offset:11216
    ds_read_b128 v[36:39], v7 offset:64
    ds_read_b128 v[40:43], v7 offset:4416
    ds_read_b128 v[44:47], v7 offset:8768
    ds_read_b128 v[48:51], v7 offset:11280
    ds_read_b128 v[52:55], v7 offset:128
    ds_read_b128 v[56:59], v7 offset:4480
    ds_read_b128 v[60:63], v7 offset:8832
    s_waitcnt lgkmcnt(8)
    ds_read_b128 v[64:67], v7 offset:11344
    ds_read_b128 v[68:71], v7 offset:192
    ds_read_b128 v[72:75], v7 offset:4544
    ds_read_b128 v[76:79], v7 offset:8896
    s_waitcnt vmcnt(0)
    v_mov_b32 v8, v96
    v_mov_b32 v9, v97
    v_mov_b32 v10, v98
    v_mov_b32 v11, v99
    s_waitcnt lgkmcnt(12)
    v_mfma_f32_16x16x32_bf16 v[80:83], v[20:23], v[16:19], v[80:83]
    v_mfma_f32_16x16x32_bf16 v[84:87], v[24:27], v[16:19], v[84:87]
    v_mfma_f32_16x16x32_bf16 v[88:91], v[28:31], v[16:19], v[88:91]
    s_waitcnt lgkmcnt(8)
    v_mfma_f32_16x16x32_bf16 v[80:83], v[36:39], v[32:35], v[80:83]
    v_mfma_f32_16x16x32_bf16 v[84:87], v[40:43], v[32:35], v[84:87]
    v_mfma_f32_16x16x32_bf16 v[88:91], v[44:47], v[32:35], v[88:91]
    s_waitcnt lgkmcnt(4)
    v_mfma_f32_16x16x32_bf16 v[80:83], v[52:55], v[48:51], v[80:83]
    v_mfma_f32_16x16x32_bf16 v[84:87], v[56:59], v[48:51], v[84:87]
    v_mfma_f32_16x16x32_bf16 v[88:91], v[60:63], v[48:51], v[88:91]
    s_waitcnt lgkmcnt(0)
    v_mfma_f32_16x16x32_bf16 v[80:83], v[68:71], v[64:67], v[80:83]
    v_mfma_f32_16x16x32_bf16 v[84:87], v[72:75], v[64:67], v[84:87]
    v_mfma_f32_16x16x32_bf16 v[88:91], v[76:79], v[64:67], v[88:91]
    s_add_u32 s54, s54, 1
    s_cmp_lt_u32 s54, 2
    s_cbranch_scc1 L_kgen
    s_cmp_ge_u32 s6, 4
    s_cbranch_scc1 L_partner
    s_barrier
    ds_read_b128 v[40:43], v125 offset:0
    ds_read_b128 v[44:47], v125 offset:1024
    ds_read_b128 v[48:51], v125 offset:2048
    s_mov_b32 s82, -1
    s_mov_b32 s83, 0xffff
    s_mov_b64 exec, s[82:83]
    ds_write_b128 v123, v[136:139]
    s_mov_b64 exec, -1
    s_waitcnt lgkmcnt(1)
    v_pk_add_f32 v[80:81], v[80:81], v[40:41]
    v_pk_add_f32 v[82:83], v[82:83], v[42:43]
    v_pk_add_f32 v[84:85], v[84:85], v[44:45]
    v_pk_add_f32 v[86:87], v[86:87], v[46:47]
    v_pk_add_f32 v[88:89], v[88:89], v[48:49]
    v_pk_add_f32 v[90:91], v[90:91], v[50:51]
    v_cvt_pk_bf16_f32 v32, v80, v81
    v_cvt_pk_bf16_f32 v33, v82, v83
    v_cvt_pk_bf16_f32 v34, v84, v85
    v_cvt_pk_bf16_f32 v35, v86, v87
    v_cvt_pk_bf16_f32 v36, v88, v89
    v_cvt_pk_bf16_f32 v37, v90, v91
    ds_write_b64 v100, v[32:33]
    ds_write_b16 v101, v34
    ds_write_b16_d16_hi v102, v34
    ds_write_b16 v103, v35
    ds_write_b16_d16_hi v104, v35
    ds_write_b16 v105, v36
    ds_write_b16_d16_hi v106, v36
    ds_write_b16 v107, v37
    ds_write_b16_d16_hi v108, v37
    ds_read_u16 v16, v110
    ds_read_u16 v52, v111
    ds_read_u16 v17, v112
    ds_read_u16 v53, v113
    s_waitcnt lgkmcnt(4)
    ds_read_u16 v18, v114
    ds_read_u16 v54, v115
    ds_read_u16 v19, v116
    ds_read_u16 v55, v117
    ds_read_u16 v20, v118
    ds_read_u16 v56, v119
    ds_read_u16 v21, v120
    ds_read_u16 v57, v121
    ds_read_u16 v64, v126 offset:320
    ds_read_u16 v65, v126 offset:288
    ds_read_u16 v66, v126 offset:256
    s_waitcnt lgkmcnt(3)
    ds_read_u16 v67, v126 offset:224
    ds_read_u16 v68, v126 offset:192
    ds_read_u16 v69, v126 offset:160
    ds_read_u16 v70, v126 offset:128
    ds_read_u16 v71, v126 offset:96
    ds_read_u16 v72, v126 offset:64
    ds_read_u16 v73, v126 offset:32
    ds_read_u16 v74, v126 offset:0
    s_mov_b64 exec, s[60:61]
    ds_write_b16 v122, v57
    s_mov_b64 exec, -1
    v_lshl_or_b32 v16, v52, 16, v16
    v_lshl_or_b32 v17, v53, 16, v17
    v_lshl_or_b32 v18, v54, 16, v18
    v_lshl_or_b32 v19, v55, 16, v19
    v_lshl_or_b32 v20, v56, 16, v20
    v_cndmask_b32 v20, v20, 0, s[58:59]
    v_cndmask_b32 v21, v21, 0, s[58:59]
    v_mov_b32 v24, v17
    v_alignbit_b32 v28, v17, v16, 16
    v_alignbit_b32 v32, v18, v17, 16
    v_mov_b32 v25, v18
    v_alignbit_b32 v29, v18, v17, 16
    v_alignbit_b32 v33, v19, v18, 16
    v_mov_b32 v26, v19
    v_alignbit_b32 v30, v19, v18, 16
    v_alignbit_b32 v34, v20, v19, 16
    v_mov_b32 v27, v20
    v_alignbit_b32 v31, v20, v19, 16
    v_alignbit_b32 v35, v21, v20, 16
    ds_write_b128 v124, v[32:35] offset:192
    ds_write_b128 v124, v[24:27] offset:1536
    ds_write_b128 v124, v[28:31] offset:2880
    ds_write_b128 v124, v[16:19] offset:4224
    v_subrev_u32 v40, 0, v127
    v_subrev_u32 v41, 1, v127
    v_subrev_u32 v42, 2, v127
    v_subrev_u32 v43, 3, v127
    v_subrev_u32 v44, 4, v127
    v_subrev_u32 v45, 5, v127
    v_subrev_u32 v46, 6, v127
    v_subrev_u32 v47, 7, v127
    v_subrev_u32 v48, 8, v127
    v_subrev_u32 v49, 9, v127
    v_subrev_u32 v50, 10, v127
    s_waitcnt lgkmcnt(5)
    v_cmp_lt_u32 vcc, v40, v128
    v_cmp_lt_u32 s[82:83], v41, v128
    s_nop 0
    v_cndmask_b32 v64, 0, v64, vcc
    v_cndmask_b32 v65, 0, v65, s[82:83]
    v_cmp_lt_u32 vcc, v42, v128
    v_cmp_lt_u32 s[82:83], v43, v128
    s_nop 0
    v_cndmask_b32 v66, 0, v66, vcc
    v_cndmask_b32 v67, 0, v67, s[82:83]
    v_cmp_lt_u32 vcc, v44, v128
    v_cmp_lt_u32 s[82:83], v45, v128
    s_nop 0
    v_cndmask_b32 v68, 0, v68, vcc
    v_cndmask_b32 v69, 0, v69, s[82:83]
    v_cmp_lt_u32 vcc, v46, v128
    v_cmp_lt_u32 s[82:83], v47, v128
    s_nop 0
    v_cndmask_b32 v70, 0, v70, vcc
    v_cndmask_b32 v71, 0, v71, s[82:83]
    v_cmp_lt_u32 vcc, v48, v128
    v_cmp_lt_u32 s[82:83], v49, v128
    s_nop 0
    v_cndmask_b32 v72, 0, v72, vcc
    v_cndmask_b32 v73, 0, v73, s[82:83]
    v_cmp_lt_u32 vcc, v50, v128
    s_nop 1
    v_cndmask_b32 v74, 0, v74, vcc
    v_lshl_or_b32 v76, v65, 16, v64
    v_lshl_or_b32 v77, v67, 16, v66
    v_lshl_or_b32 v78, v69, 16, v68
    v_lshl_or_b32 v79, v71, 16, v70
    v_lshl_or_b32 v80, v73, 16, v72
    v_mov_b32 v81, v74
    s_mov_b32 s82, -1
    s_mov_b32 s83, 0xfffff
    s_mov_b64 exec, s[82:83]
    v_mov_b32 v84, v77
    v_alignbit_b32 v88, v77, v76, 16
    v_alignbit_b32 v92, v78, v77, 16
    v_mov_b32 v85, v78
    v_alignbit_b32 v89, v78, v77, 16
    v_alignbit_b32 v93, v79, v78, 16
    v_mov_b32 v86, v79
    v_alignbit_b32 v90, v79, v78, 16
    v_alignbit_b32 v94, v80, v79, 16
    v_mov_b32 v87, v80
    v_alignbit_b32 v91, v80, v79, 16
    v_alignbit_b32 v95, v81, v80, 16
    ds_write_b128 v129, v[92:95]
    ds_write_b128 v130, v[84:87]
    ds_write_b128 v131, v[88:91]
    ds_write_b128 v132, v[76:79]
    s_mov_b64 exec, -1
    v_lshlrev_b32 v240, 16, v240
    v_lshrrev_b32 v144, 3, v4
    s_mov_b32 s63, 163840
    v_mul_lo_u32 v144, v144, s63
    v_and_b32 v145, 7, v4
    v_lshl_add_u32 v144, v145, 5, v144
    v_lshl_add_u32 v175, v3, 3, v144
    s_add_u32 s36, s4, 0x700000
    s_addc_u32 s37, s5, 0
    s_mov_b32 s38, 2621440
    s_mov_b32 s39, 0x20000
    s_lshl_b32 s55, s52, 8
    s_waitcnt lgkmcnt(0)
    s_barrier
    ds_read_b64 v[48:49], v168 offset:1152
    ds_read_b64 v[50:51], v168 offset:1160
    ds_read_b128 v[56:59], v169 offset:448
    ds_read_b128 v[60:63], v169 offset:960
    ds_read_b128 v[64:67], v169 offset:1472
    ds_read_b128 v[68:71], v169 offset:1984
    ds_read_b128 v[72:75], v169 offset:2496
    ds_read_b128 v[76:79], v169 offset:3008
    ds_read_b128 v[80:83], v169 offset:3520
    ds_read_b128 v[84:87], v169 offset:4032
    ds_read_b64 v[52:53], v168 offset:640
    ds_read_b64 v[54:55], v168 offset:648
    s_waitcnt lgkmcnt(6)
    ds_read_b64 v[128:129], v168 offset:128
    ds_read_b64 v[130:131], v168 offset:136
    ds_read_b64 v[132:133], v168 offset:0
    ds_read_b64 v[134:135], v168 offset:8
    s_waitcnt lgkmcnt(0)
    v_mfma_f32_16x16x32_bf16 v[16:19], v[48:51], v[56:59], 0
    ds_read_b64 v[88:89], v168 offset:1088
    ds_read_b64 v[90:91], v168 offset:1096
    v_mfma_f32_16x16x32_bf16 v[20:23], v[48:51], v[60:63], 0
    ds_read_b128 v[96:99], v169 offset:384
    ds_read_b128 v[100:103], v169 offset:896
    v_mfma_f32_16x16x32_bf16 v[24:27], v[48:51], v[64:67], 0
    ds_read_b128 v[104:107], v169 offset:1408
    ds_read_b128 v[108:111], v169 offset:1920
    v_mfma_f32_16x16x32_bf16 v[28:31], v[48:51], v[68:71], 0
    ds_read_b128 v[112:115], v169 offset:2432
    ds_read_b128 v[116:119], v169 offset:2944
    v_mfma_f32_16x16x32_bf16 v[32:35], v[48:51], v[72:75], 0
    ds_read_b128 v[120:123], v169 offset:3456
    ds_read_b128 v[124:127], v169 offset:3968
    v_mfma_f32_16x16x32_bf16 v[36:39], v[48:51], v[76:79], 0
    ds_read_b64 v[92:93], v168 offset:576
    v_mfma_f32_16x16x32_bf16 v[40:43], v[48:51], v[80:83], 0
    ds_read_b64 v[94:95], v168 offset:584
    v_mfma_f32_16x16x32_bf16 v[44:47], v[48:51], v[84:87], 0
    s_waitcnt lgkmcnt(4)
    v_mfma_f32_16x16x32_bf16 v[20:23], v[52:55], v[56:59], v[20:23]
    ds_read_b64 v[178:179], v174 offset:9184
    v_mfma_f32_16x16x32_bf16 v[24:27], v[52:55], v[60:63], v[24:27]
    ds_read_b64 v[182:183], v174 offset:9696
    v_mfma_f32_16x16x32_bf16 v[28:31], v[52:55], v[64:67], v[28:31]
    ds_read_b64 v[186:187], v174 offset:10208
    v_mfma_f32_16x16x32_bf16 v[32:35], v[52:55], v[68:71], v[32:35]
    ds_read_b64 v[190:191], v174 offset:10720
    v_mfma_f32_16x16x32_bf16 v[36:39], v[52:55], v[72:75], v[36:39]
    ds_read_b64 v[194:195], v174 offset:11232
    v_mfma_f32_16x16x32_bf16 v[40:43], v[52:55], v[76:79], v[40:43]
    ds_read_b64 v[198:199], v174 offset:11744
    v_mfma_f32_16x16x32_bf16 v[44:47], v[52:55], v[80:83], v[44:47]
    ds_read_b64 v[202:203], v174 offset:12256
    v_mfma_f32_16x16x32_bf16 v[24:27], v[128:131], v[56:59], v[24:27]
    ds_read_b64 v[206:207], v174 offset:12768
    v_mfma_f32_16x16x32_bf16 v[28:31], v[128:131], v[60:63], v[28:31]
    s_waitcnt lgkmcnt(6)
    v_mfma_f32_16x16x32_bf16 v[32:35], v[128:131], v[64:67], v[32:35]
    ds_read_b64 v[210:211], v174 offset:13312
    v_mfma_f32_16x16x32_bf16 v[36:39], v[128:131], v[68:71], v[36:39]
    ds_read_b64 v[214:215], v174 offset:13824
    v_mfma_f32_16x16x32_bf16 v[40:43], v[128:131], v[72:75], v[40:43]
    ds_read_b64 v[218:219], v174 offset:14336
    v_mfma_f32_16x16x32_bf16 v[44:47], v[128:131], v[76:79], v[44:47]
    ds_read_b64 v[222:223], v174 offset:14848
    v_mfma_f32_16x16x32_bf16 v[32:35], v[132:135], v[56:59], v[32:35]
    ds_read_b64 v[226:227], v174 offset:15360
    v_mfma_f32_16x16x32_bf16 v[36:39], v[132:135], v[60:63], v[36:39]
    ds_read_b64 v[230:231], v174 offset:15872
    v_mfma_f32_16x16x32_bf16 v[40:43], v[132:135], v[64:67], v[40:43]
    ds_read_b64 v[234:235], v174 offset:16384
    v_mfma_f32_16x16x32_bf16 v[44:47], v[132:135], v[68:71], v[44:47]
    ds_read_b64 v[238:239], v174 offset:16896
    s_waitcnt lgkmcnt(0)
    v_mfma_f32_16x16x32_bf16 v[16:19], v[88:91], v[96:99], v[16:19]
    ds_read_b64 v[48:49], v168 offset:1024
    ds_read_b64 v[50:51], v168 offset:1032
    v_mfma_f32_16x16x32_bf16 v[20:23], v[88:91], v[100:103], v[20:23]
    ds_read_b128 v[56:59], v169 offset:320
    ds_read_b128 v[60:63], v169 offset:832
    v_mfma_f32_16x16x32_bf16 v[24:27], v[88:91], v[104:107], v[24:27]
    ds_read_b128 v[64:67], v169 offset:1344
    ds_read_b128 v[68:71], v169 offset:1856
    v_mfma_f32_16x16x32_bf16 v[28:31], v[88:91], v[108:111], v[28:31]
    ds_read_b128 v[72:75], v169 offset:2368
    ds_read_b128 v[76:79], v169 offset:2880
    v_mfma_f32_16x16x32_bf16 v[32:35], v[88:91], v[112:115], v[32:35]
    ds_read_b128 v[80:83], v169 offset:3392
    ds_read_b128 v[84:87], v169 offset:3904
    v_mfma_f32_16x16x32_bf16 v[36:39], v[88:91], v[116:119], v[36:39]
    ds_read_b64 v[52:53], v168 offset:512
    ds_read_b64 v[54:55], v168 offset:520
    v_mfma_f32_16x16x32_bf16 v[40:43], v[88:91], v[120:123], v[40:43]
    v_lshlrev_b32 v176, 16, v178
    v_and_b32 v177, 0xffff0000, v178
    v_mfma_f32_16x16x32_bf16 v[44:47], v[88:91], v[124:127], v[44:47]
    v_pk_mul_f32 v[176:177], v[176:177], v[240:241] op_sel_hi:[1,0]
    v_cvt_pk_bf16_f32 v176, v176, v177
    v_mfma_f32_16x16x32_bf16 v[20:23], v[92:95], v[96:99], v[20:23]
    v_and_b32 v177, 0xffff0000, v176
    v_lshlrev_b32 v176, 16, v176
    v_mfma_f32_16x16x32_bf16 v[24:27], v[92:95], v[100:103], v[24:27]
    v_lshlrev_b32 v178, 16, v179
    v_and_b32 v179, 0xffff0000, v179
    v_mfma_f32_16x16x32_bf16 v[28:31], v[92:95], v[104:107], v[28:31]
    v_pk_mul_f32 v[178:179], v[178:179], v[240:241] op_sel_hi:[1,0]
    v_cvt_pk_bf16_f32 v178, v178, v179
    v_mfma_f32_16x16x32_bf16 v[32:35], v[92:95], v[108:111], v[32:35]
    v_and_b32 v179, 0xffff0000, v178
    v_lshlrev_b32 v178, 16, v178
    v_mfma_f32_16x16x32_bf16 v[36:39], v[92:95], v[112:115], v[36:39]
    v_lshlrev_b32 v180, 16, v182
    v_and_b32 v181, 0xffff0000, v182
    v_mfma_f32_16x16x32_bf16 v[40:43], v[92:95], v[116:119], v[40:43]
    v_pk_mul_f32 v[180:181], v[180:181], v[240:241] op_sel_hi:[1,0]
    v_mfma_f32_16x16x32_bf16 v[44:47], v[92:95], v[120:123], v[44:47]
    v_cvt_pk_bf16_f32 v180, v180, v181
    s_waitcnt lgkmcnt(0)
    v_mfma_f32_16x16x32_bf16 v[16:19], v[48:51], v[56:59], v[16:19]
    ds_read_b64 v[88:89], v168 offset:960
    ds_read_b64 v[90:91], v168 offset:968
    v_mfma_f32_16x16x32_bf16 v[20:23], v[48:51], v[60:63], v[20:23]
    ds_read_b128 v[96:99], v169 offset:256
    ds_read_b128 v[100:103], v169 offset:768
    v_mfma_f32_16x16x32_bf16 v[24:27], v[48:51], v[64:67], v[24:27]
    ds_read_b128 v[104:107], v169 offset:1280
    ds_read_b128 v[108:111], v169 offset:1792
    v_mfma_f32_16x16x32_bf16 v[28:31], v[48:51], v[68:71], v[28:31]
    ds_read_b128 v[112:115], v169 offset:2304
    ds_read_b128 v[116:119], v169 offset:2816
    v_mfma_f32_16x16x32_bf16 v[32:35], v[48:51], v[72:75], v[32:35]
    ds_read_b128 v[120:123], v169 offset:3328
    ds_read_b128 v[124:127], v169 offset:3840
    v_mfma_f32_16x16x32_bf16 v[36:39], v[48:51], v[76:79], v[36:39]
    ds_read_b64 v[92:93], v168 offset:448
    ds_read_b64 v[94:95], v168 offset:456
    v_mfma_f32_16x16x32_bf16 v[40:43], v[48:51], v[80:83], v[40:43]
    v_and_b32 v181, 0xffff0000, v180
    v_lshlrev_b32 v180, 16, v180
    v_mfma_f32_16x16x32_bf16 v[44:47], v[48:51], v[84:87], v[44:47]
    v_lshlrev_b32 v182, 16, v183
    v_and_b32 v183, 0xffff0000, v183
    v_mfma_f32_16x16x32_bf16 v[20:23], v[52:55], v[56:59], v[20:23]
    v_pk_mul_f32 v[182:183], v[182:183], v[240:241] op_sel_hi:[1,0]
    v_cvt_pk_bf16_f32 v182, v182, v183
    v_mfma_f32_16x16x32_bf16 v[24:27], v[52:55], v[60:63], v[24:27]
    v_and_b32 v183, 0xffff0000, v182
    v_lshlrev_b32 v182, 16, v182
    v_mfma_f32_16x16x32_bf16 v[28:31], v[52:55], v[64:67], v[28:31]
    v_lshlrev_b32 v184, 16, v186
    v_and_b32 v185, 0xffff0000, v186
    v_mfma_f32_16x16x32_bf16 v[32:35], v[52:55], v[68:71], v[32:35]
    v_pk_mul_f32 v[184:185], v[184:185], v[240:241] op_sel_hi:[1,0]
    v_cvt_pk_bf16_f32 v184, v184, v185
    v_mfma_f32_16x16x32_bf16 v[36:39], v[52:55], v[72:75], v[36:39]
    v_and_b32 v185, 0xffff0000, v184
    v_lshlrev_b32 v184, 16, v184
    v_mfma_f32_16x16x32_bf16 v[40:43], v[52:55], v[76:79], v[40:43]
    v_lshlrev_b32 v186, 16, v187
    v_mfma_f32_16x16x32_bf16 v[44:47], v[52:55], v[80:83], v[44:47]
    v_and_b32 v187, 0xffff0000, v187
    s_waitcnt lgkmcnt(0)
    v_mfma_f32_16x16x32_bf16 v[16:19], v[88:91], v[96:99], v[16:19]
    ds_read_b64 v[48:49], v168 offset:896
    ds_read_b64 v[50:51], v168 offset:904
    v_mfma_f32_16x16x32_bf16 v[20:23], v[88:91], v[100:103], v[20:23]
    ds_read_b128 v[56:59], v169 offset:192
    ds_read_b128 v[60:63], v169 offset:704
    v_mfma_f32_16x16x32_bf16 v[24:27], v[88:91], v[104:107], v[24:27]
    ds_read_b128 v[64:67], v169 offset:1216
    ds_read_b128 v[68:71], v169 offset:1728
    v_mfma_f32_16x16x32_bf16 v[28:31], v[88:91], v[108:111], v[28:31]
    ds_read_b128 v[72:75], v169 offset:2240
    ds_read_b128 v[76:79], v169 offset:2752
    v_mfma_f32_16x16x32_bf16 v[32:35], v[88:91], v[112:115], v[32:35]
    ds_read_b128 v[80:83], v169 offset:3264
    ds_read_b128 v[84:87], v169 offset:3776
    v_mfma_f32_16x16x32_bf16 v[36:39], v[88:91], v[116:119], v[36:39]
    ds_read_b64 v[52:53], v168 offset:384
    ds_read_b64 v[54:55], v168 offset:392
    v_mfma_f32_16x16x32_bf16 v[40:43], v[88:91], v[120:123], v[40:43]
    v_pk_mul_f32 v[186:187], v[186:187], v[240:241] op_sel_hi:[1,0]
    v_cvt_pk_bf16_f32 v186, v186, v187
    v_mfma_f32_16x16x32_bf16 v[44:47], v[88:91], v[124:127], v[44:47]
    v_and_b32 v187, 0xffff0000, v186
    v_lshlrev_b32 v186, 16, v186
    v_mfma_f32_16x16x32_bf16 v[20:23], v[92:95], v[96:99], v[20:23]
    v_lshlrev_b32 v188, 16, v190
    v_and_b32 v189, 0xffff0000, v190
    v_mfma_f32_16x16x32_bf16 v[24:27], v[92:95], v[100:103], v[24:27]
    v_pk_mul_f32 v[188:189], v[188:189], v[240:241] op_sel_hi:[1,0]
    v_cvt_pk_bf16_f32 v188, v188, v189
    v_mfma_f32_16x16x32_bf16 v[28:31], v[92:95], v[104:107], v[28:31]
    v_and_b32 v189, 0xffff0000, v188
    v_lshlrev_b32 v188, 16, v188
    v_mfma_f32_16x16x32_bf16 v[32:35], v[92:95], v[108:111], v[32:35]
    v_lshlrev_b32 v190, 16, v191
    v_and_b32 v191, 0xffff0000, v191
    v_mfma_f32_16x16x32_bf16 v[36:39], v[92:95], v[112:115], v[36:39]
    v_pk_mul_f32 v[190:191], v[190:191], v[240:241] op_sel_hi:[1,0]
    v_cvt_pk_bf16_f32 v190, v190, v191
    v_mfma_f32_16x16x32_bf16 v[40:43], v[92:95], v[116:119], v[40:43]
    v_and_b32 v191, 0xffff0000, v190
    v_mfma_f32_16x16x32_bf16 v[44:47], v[92:95], v[120:123], v[44:47]
    v_lshlrev_b32 v190, 16, v190
    s_waitcnt lgkmcnt(0)
    v_mfma_f32_16x16x32_bf16 v[16:19], v[48:51], v[56:59], v[16:19]
    ds_read_b64 v[88:89], v168 offset:832
    ds_read_b64 v[90:91], v168 offset:840
    v_mfma_f32_16x16x32_bf16 v[20:23], v[48:51], v[60:63], v[20:23]
    ds_read_b128 v[96:99], v169 offset:128
    ds_read_b128 v[100:103], v169 offset:640
    v_mfma_f32_16x16x32_bf16 v[24:27], v[48:51], v[64:67], v[24:27]
    ds_read_b128 v[104:107], v169 offset:1152
    ds_read_b128 v[108:111], v169 offset:1664
    v_mfma_f32_16x16x32_bf16 v[28:31], v[48:51], v[68:71], v[28:31]
    ds_read_b128 v[112:115], v169 offset:2176
    ds_read_b128 v[116:119], v169 offset:2688
    v_mfma_f32_16x16x32_bf16 v[32:35], v[48:51], v[72:75], v[32:35]
    ds_read_b128 v[120:123], v169 offset:3200
    ds_read_b128 v[124:127], v169 offset:3712
    v_mfma_f32_16x16x32_bf16 v[36:39], v[48:51], v[76:79], v[36:39]
    ds_read_b64 v[92:93], v168 offset:320
    ds_read_b64 v[94:95], v168 offset:328
    v_mfma_f32_16x16x32_bf16 v[40:43], v[48:51], v[80:83], v[40:43]
    v_lshlrev_b32 v192, 16, v194
    v_and_b32 v193, 0xffff0000, v194
    v_mfma_f32_16x16x32_bf16 v[44:47], v[48:51], v[84:87], v[44:47]
    v_pk_mul_f32 v[192:193], v[192:193], v[240:241] op_sel_hi:[1,0]
    v_cvt_pk_bf16_f32 v192, v192, v193
    v_mfma_f32_16x16x32_bf16 v[20:23], v[52:55], v[56:59], v[20:23]
    v_and_b32 v193, 0xffff0000, v192
    v_lshlrev_b32 v192, 16, v192
    v_mfma_f32_16x16x32_bf16 v[24:27], v[52:55], v[60:63], v[24:27]
    v_lshlrev_b32 v194, 16, v195
    v_and_b32 v195, 0xffff0000, v195
    v_mfma_f32_16x16x32_bf16 v[28:31], v[52:55], v[64:67], v[28:31]
    v_pk_mul_f32 v[194:195], v[194:195], v[240:241] op_sel_hi:[1,0]
    v_cvt_pk_bf16_f32 v194, v194, v195
    v_mfma_f32_16x16x32_bf16 v[32:35], v[52:55], v[68:71], v[32:35]
    v_and_b32 v195, 0xffff0000, v194
    v_lshlrev_b32 v194, 16, v194
    v_mfma_f32_16x16x32_bf16 v[36:39], v[52:55], v[72:75], v[36:39]
    v_lshlrev_b32 v196, 16, v198
    v_and_b32 v197, 0xffff0000, v198
    v_mfma_f32_16x16x32_bf16 v[40:43], v[52:55], v[76:79], v[40:43]
    v_pk_mul_f32 v[196:197], v[196:197], v[240:241] op_sel_hi:[1,0]
    v_mfma_f32_16x16x32_bf16 v[44:47], v[52:55], v[80:83], v[44:47]
    v_cvt_pk_bf16_f32 v196, v196, v197
    s_waitcnt lgkmcnt(0)
    v_mfma_f32_16x16x32_bf16 v[16:19], v[88:91], v[96:99], v[16:19]
    ds_read_b64 v[48:49], v168 offset:768
    ds_read_b64 v[50:51], v168 offset:776
    v_mfma_f32_16x16x32_bf16 v[20:23], v[88:91], v[100:103], v[20:23]
    ds_read_b128 v[56:59], v169 offset:64
    ds_read_b128 v[60:63], v169 offset:576
    v_mfma_f32_16x16x32_bf16 v[24:27], v[88:91], v[104:107], v[24:27]
    ds_read_b128 v[64:67], v169 offset:1088
    ds_read_b128 v[68:71], v169 offset:1600
    v_mfma_f32_16x16x32_bf16 v[28:31], v[88:91], v[108:111], v[28:31]
    ds_read_b128 v[72:75], v169 offset:2112
    ds_read_b128 v[76:79], v169 offset:2624
    v_mfma_f32_16x16x32_bf16 v[32:35], v[88:91], v[112:115], v[32:35]
    ds_read_b128 v[80:83], v169 offset:3136
    ds_read_b128 v[84:87], v169 offset:3648
    v_mfma_f32_16x16x32_bf16 v[36:39], v[88:91], v[116:119], v[36:39]
    ds_read_b64 v[52:53], v168 offset:256
    ds_read_b64 v[54:55], v168 offset:264
    v_mfma_f32_16x16x32_bf16 v[40:43], v[88:91], v[120:123], v[40:43]
    v_and_b32 v197, 0xffff0000, v196
    v_lshlrev_b32 v196, 16, v196
    v_mfma_f32_16x16x32_bf16 v[44:47], v[88:91], v[124:127], v[44:47]
    v_lshlrev_b32 v198, 16, v199
    v_and_b32 v199, 0xffff0000, v199
    v_mfma_f32_16x16x32_bf16 v[20:23], v[92:95], v[96:99], v[20:23]
    v_pk_mul_f32 v[198:199], v[198:199], v[240:241] op_sel_hi:[1,0]
    v_cvt_pk_bf16_f32 v198, v198, v199
    v_mfma_f32_16x16x32_bf16 v[24:27], v[92:95], v[100:103], v[24:27]
    v_and_b32 v199, 0xffff0000, v198
    v_lshlrev_b32 v198, 16, v198
    v_mfma_f32_16x16x32_bf16 v[28:31], v[92:95], v[104:107], v[28:31]
    v_lshlrev_b32 v200, 16, v202
    v_and_b32 v201, 0xffff0000, v202
    v_mfma_f32_16x16x32_bf16 v[32:35], v[92:95], v[108:111], v[32:35]
    v_pk_mul_f32 v[200:201], v[200:201], v[240:241] op_sel_hi:[1,0]
    v_cvt_pk_bf16_f32 v200, v200, v201
    v_mfma_f32_16x16x32_bf16 v[36:39], v[92:95], v[112:115], v[36:39]
    v_and_b32 v201, 0xffff0000, v200
    v_lshlrev_b32 v200, 16, v200
    v_mfma_f32_16x16x32_bf16 v[40:43], v[92:95], v[116:119], v[40:43]
    v_lshlrev_b32 v202, 16, v203
    v_mfma_f32_16x16x32_bf16 v[44:47], v[92:95], v[120:123], v[44:47]
    v_and_b32 v203, 0xffff0000, v203
    s_waitcnt lgkmcnt(0)
    v_mfma_f32_16x16x32_bf16 v[16:19], v[48:51], v[56:59], v[16:19]
    ds_read_b64 v[88:89], v168 offset:704
    ds_read_b64 v[90:91], v168 offset:712
    v_mfma_f32_16x16x32_bf16 v[20:23], v[48:51], v[60:63], v[20:23]
    ds_read_b128 v[96:99], v169 offset:0
    ds_read_b128 v[100:103], v169 offset:512
    v_mfma_f32_16x16x32_bf16 v[24:27], v[48:51], v[64:67], v[24:27]
    ds_read_b128 v[104:107], v169 offset:1024
    ds_read_b128 v[108:111], v169 offset:1536
    v_mfma_f32_16x16x32_bf16 v[28:31], v[48:51], v[68:71], v[28:31]
    ds_read_b128 v[112:115], v169 offset:2048
    ds_read_b128 v[116:119], v169 offset:2560
    v_mfma_f32_16x16x32_bf16 v[32:35], v[48:51], v[72:75], v[32:35]
    ds_read_b128 v[120:123], v169 offset:3072
    ds_read_b128 v[124:127], v169 offset:3584
    v_mfma_f32_16x16x32_bf16 v[36:39], v[48:51], v[76:79], v[36:39]
    ds_read_b64 v[92:93], v168 offset:192
    ds_read_b64 v[94:95], v168 offset:200
    v_mfma_f32_16x16x32_bf16 v[40:43], v[48:51], v[80:83], v[40:43]
    v_pk_mul_f32 v[202:203], v[202:203], v[240:241] op_sel_hi:[1,0]
    v_cvt_pk_bf16_f32 v202, v202, v203
    v_mfma_f32_16x16x32_bf16 v[44:47], v[48:51], v[84:87], v[44:47]
    v_and_b32 v203, 0xffff0000, v202
    v_lshlrev_b32 v202, 16, v202
    v_mfma_f32_16x16x32_bf16 v[20:23], v[52:55], v[56:59], v[20:23]
    v_lshlrev_b32 v204, 16, v206
    v_and_b32 v205, 0xffff0000, v206
    v_mfma_f32_16x16x32_bf16 v[24:27], v[52:55], v[60:63], v[24:27]
    v_pk_mul_f32 v[204:205], v[204:205], v[240:241] op_sel_hi:[1,0]
    v_cvt_pk_bf16_f32 v204, v204, v205
    v_mfma_f32_16x16x32_bf16 v[28:31], v[52:55], v[64:67], v[28:31]
    v_and_b32 v205, 0xffff0000, v204
    v_lshlrev_b32 v204, 16, v204
    v_mfma_f32_16x16x32_bf16 v[32:35], v[52:55], v[68:71], v[32:35]
    v_lshlrev_b32 v206, 16, v207
    v_and_b32 v207, 0xffff0000, v207
    v_mfma_f32_16x16x32_bf16 v[36:39], v[52:55], v[72:75], v[36:39]
    v_pk_mul_f32 v[206:207], v[206:207], v[240:241] op_sel_hi:[1,0]
    v_cvt_pk_bf16_f32 v206, v206, v207
    v_mfma_f32_16x16x32_bf16 v[40:43], v[52:55], v[76:79], v[40:43]
    v_and_b32 v207, 0xffff0000, v206
    v_mfma_f32_16x16x32_bf16 v[44:47], v[52:55], v[80:83], v[44:47]
    v_lshlrev_b32 v206, 16, v206
    s_waitcnt lgkmcnt(0)
    s_barrier
    v_mfma_f32_16x16x32_bf16 v[16:19], v[88:91], v[96:99], v[16:19]
    ds_read_b64 v[128:129], v170 offset:64
    ds_read_b64 v[130:131], v170 offset:80
    v_mfma_f32_16x16x32_bf16 v[20:23], v[88:91], v[100:103], v[20:23]
    ds_read_b64 v[132:133], v170 offset:32
    ds_read_b64 v[134:135], v170 offset:48
    v_mfma_f32_16x16x32_bf16 v[24:27], v[88:91], v[104:107], v[24:27]
    ds_read_b64 v[136:137], v170 offset:0
    ds_read_b64 v[138:139], v170 offset:16
    v_mfma_f32_16x16x32_bf16 v[28:31], v[88:91], v[108:111], v[28:31]
    ds_read_b64_tr_b16 v[48:49], v172 offset:16
    ds_read_b64_tr_b16 v[50:51], v172 offset:272
    v_mfma_f32_16x16x32_bf16 v[32:35], v[88:91], v[112:115], v[32:35]
    ds_read_b64_tr_b16 v[52:53], v172 offset:528
    ds_read_b64_tr_b16 v[54:55], v172 offset:784
    v_mfma_f32_16x16x32_bf16 v[36:39], v[88:91], v[116:119], v[36:39]
    ds_read_b64_tr_b16 v[56:57], v172 offset:1040
    ds_read_b64_tr_b16 v[58:59], v172 offset:1296
    v_mfma_f32_16x16x32_bf16 v[40:43], v[88:91], v[120:123], v[40:43]
    s_waitcnt lgkmcnt(4)
    ds_read_b64_tr_b16 v[60:61], v172 offset:1552
    v_mfma_f32_16x16x32_bf16 v[44:47], v[88:91], v[124:127], v[44:47]
    ds_read_b64_tr_b16 v[62:63], v172 offset:1808
    ds_read_b64_tr_b16 v[64:65], v172 offset:2064
    v_mfma_f32_16x16x32_bf16 v[20:23], v[92:95], v[96:99], v[20:23]
    ds_read_b64_tr_b16 v[66:67], v172 offset:2320
    ds_read_b64_tr_b16 v[68:69], v172 offset:2576
    v_mfma_f32_16x16x32_bf16 v[24:27], v[92:95], v[100:103], v[24:27]
    ds_read_b64_tr_b16 v[70:71], v172 offset:2832
    ds_read_b64 v[140:141], v170 offset:1088
    v_mfma_f32_16x16x32_bf16 v[28:31], v[92:95], v[104:107], v[28:31]
    ds_read_b64 v[142:143], v170 offset:1104
    v_mfma_f32_16x16x32_bf16 v[32:35], v[92:95], v[108:111], v[32:35]
    ds_read_b64 v[144:145], v170 offset:1056
    v_mfma_f32_16x16x32_bf16 v[36:39], v[92:95], v[112:115], v[36:39]
    ds_read_b64 v[146:147], v170 offset:1072
    v_mfma_f32_16x16x32_bf16 v[40:43], v[92:95], v[116:119], v[40:43]
    ds_read_b64 v[148:149], v170 offset:1024
    v_mfma_f32_16x16x32_bf16 v[44:47], v[92:95], v[120:123], v[44:47]
    ds_read_b64 v[150:151], v170 offset:1040
    s_waitcnt lgkmcnt(0)
    v_mfma_f32_16x16x32_bf16 v[24:27], v[48:51], v[128:131], v[24:27]
    ds_read_b64_tr_b16 v[88:89], v172 offset:0
    ds_read_b64_tr_b16 v[90:91], v172 offset:256
    v_mfma_f32_16x16x32_bf16 v[28:31], v[52:55], v[128:131], v[28:31]
    ds_read_b64_tr_b16 v[92:93], v172 offset:512
    ds_read_b64_tr_b16 v[94:95], v172 offset:768
    v_mfma_f32_16x16x32_bf16 v[32:35], v[56:59], v[128:131], v[32:35]
    ds_read_b64_tr_b16 v[96:97], v172 offset:1024
    ds_read_b64_tr_b16 v[98:99], v172 offset:1280
    v_mfma_f32_16x16x32_bf16 v[36:39], v[60:63], v[128:131], v[36:39]
    ds_read_b64_tr_b16 v[100:101], v172 offset:1536
    ds_read_b64_tr_b16 v[102:103], v172 offset:1792
    v_mfma_f32_16x16x32_bf16 v[40:43], v[64:67], v[128:131], v[40:43]
    ds_read_b64_tr_b16 v[104:105], v172 offset:2048
    ds_read_b64_tr_b16 v[106:107], v172 offset:2304
    v_mfma_f32_16x16x32_bf16 v[44:47], v[68:71], v[128:131], v[44:47]
    ds_read_b64_tr_b16 v[108:109], v172 offset:2560
    ds_read_b64_tr_b16 v[110:111], v172 offset:2816
    v_mfma_f32_16x16x32_bf16 v[28:31], v[48:51], v[132:135], v[28:31]
    s_waitcnt lgkmcnt(2)
    ds_read_b64_tr_b16 v[72:73], v173 offset:0
    v_mfma_f32_16x16x32_bf16 v[32:35], v[52:55], v[132:135], v[32:35]
    ds_read_b64_tr_b16 v[74:75], v173 offset:256
    ds_read_b64 v[152:153], v171 offset:96
    v_mfma_f32_16x16x32_bf16 v[36:39], v[56:59], v[132:135], v[36:39]
    ds_read_b64 v[154:155], v171 offset:112
    ds_read_b64_tr_b16 v[76:77], v173 offset:512
    v_mfma_f32_16x16x32_bf16 v[40:43], v[60:63], v[132:135], v[40:43]
    ds_read_b64_tr_b16 v[78:79], v173 offset:768
    ds_read_b64 v[156:157], v171 offset:64
    v_mfma_f32_16x16x32_bf16 v[44:47], v[64:67], v[132:135], v[44:47]
    ds_read_b64 v[158:159], v171 offset:80
    v_mfma_f32_16x16x32_bf16 v[32:35], v[48:51], v[136:139], v[32:35]
    ds_read_b64_tr_b16 v[80:81], v173 offset:1024
    v_mfma_f32_16x16x32_bf16 v[36:39], v[52:55], v[136:139], v[36:39]
    ds_read_b64_tr_b16 v[82:83], v173 offset:1280
    v_mfma_f32_16x16x32_bf16 v[40:43], v[56:59], v[136:139], v[40:43]
    ds_read_b64 v[160:161], v171 offset:32
    v_mfma_f32_16x16x32_bf16 v[44:47], v[60:63], v[136:139], v[44:47]
    ds_read_b64 v[162:163], v171 offset:48
    s_waitcnt lgkmcnt(12)
    v_mfma_f32_16x16x32_bf16 v[24:27], v[88:91], v[140:143], v[24:27]
    ds_read_b64_tr_b16 v[84:85], v173 offset:1536
    ds_read_b64_tr_b16 v[86:87], v173 offset:1792
    v_mfma_f32_16x16x32_bf16 v[28:31], v[92:95], v[140:143], v[28:31]
    ds_read_b64 v[164:165], v171 offset:0
    ds_read_b64 v[166:167], v171 offset:16
    v_mfma_f32_16x16x32_bf16 v[32:35], v[96:99], v[140:143], v[32:35]
    v_lshlrev_b32 v208, 16, v210
    v_and_b32 v209, 0xffff0000, v210
    v_mfma_f32_16x16x32_bf16 v[36:39], v[100:103], v[140:143], v[36:39]
    v_lshlrev_b32 v210, 16, v211
    v_and_b32 v211, 0xffff0000, v211
    v_mfma_f32_16x16x32_bf16 v[40:43], v[104:107], v[140:143], v[40:43]
    v_lshlrev_b32 v212, 16, v214
    v_and_b32 v213, 0xffff0000, v214
    v_mfma_f32_16x16x32_bf16 v[44:47], v[108:111], v[140:143], v[44:47]
    v_lshlrev_b32 v214, 16, v215
    v_and_b32 v215, 0xffff0000, v215
    v_mfma_f32_16x16x32_bf16 v[28:31], v[88:91], v[144:147], v[28:31]
    v_lshlrev_b32 v216, 16, v218
    v_and_b32 v217, 0xffff0000, v218
    v_mfma_f32_16x16x32_bf16 v[32:35], v[92:95], v[144:147], v[32:35]
    v_lshlrev_b32 v218, 16, v219
    v_and_b32 v219, 0xffff0000, v219
    v_mfma_f32_16x16x32_bf16 v[36:39], v[96:99], v[144:147], v[36:39]
    v_lshlrev_b32 v220, 16, v222
    v_and_b32 v221, 0xffff0000, v222
    v_mfma_f32_16x16x32_bf16 v[40:43], v[100:103], v[144:147], v[40:43]
    v_lshlrev_b32 v222, 16, v223
    v_mfma_f32_16x16x32_bf16 v[44:47], v[104:107], v[144:147], v[44:47]
    v_and_b32 v223, 0xffff0000, v223
    v_mfma_f32_16x16x32_bf16 v[32:35], v[88:91], v[148:151], v[32:35]
    v_lshlrev_b32 v224, 16, v226
    v_mfma_f32_16x16x32_bf16 v[36:39], v[92:95], v[148:151], v[36:39]
    v_and_b32 v225, 0xffff0000, v226
    v_mfma_f32_16x16x32_bf16 v[40:43], v[96:99], v[148:151], v[40:43]
    v_lshlrev_b32 v226, 16, v227
    v_mfma_f32_16x16x32_bf16 v[44:47], v[100:103], v[148:151], v[44:47]
    v_and_b32 v227, 0xffff0000, v227
    s_waitcnt lgkmcnt(0)
    v_mfma_f32_16x16x32_bf16 v[32:35], v[72:75], v[152:155], v[32:35]
    v_lshlrev_b32 v228, 16, v230
    v_and_b32 v229, 0xffff0000, v230
    v_mfma_f32_16x16x32_bf16 v[36:39], v[76:79], v[152:155], v[36:39]
    v_lshlrev_b32 v230, 16, v231
    v_and_b32 v231, 0xffff0000, v231
    v_mfma_f32_16x16x32_bf16 v[40:43], v[80:83], v[152:155], v[40:43]
    v_lshlrev_b32 v232, 16, v234
    v_mfma_f32_16x16x32_bf16 v[44:47], v[84:87], v[152:155], v[44:47]
    v_and_b32 v233, 0xffff0000, v234
    v_mfma_f32_16x16x32_bf16 v[36:39], v[72:75], v[156:159], v[36:39]
    v_lshlrev_b32 v234, 16, v235
    v_mfma_f32_16x16x32_bf16 v[40:43], v[76:79], v[156:159], v[40:43]
    v_and_b32 v235, 0xffff0000, v235
    v_mfma_f32_16x16x32_bf16 v[44:47], v[80:83], v[156:159], v[44:47]
    v_lshlrev_b32 v236, 16, v238
    v_mfma_f32_16x16x32_bf16 v[40:43], v[72:75], v[160:163], v[40:43]
    v_and_b32 v237, 0xffff0000, v238
    v_mfma_f32_16x16x32_bf16 v[44:47], v[76:79], v[160:163], v[44:47]
    v_lshlrev_b32 v238, 16, v239
    v_mfma_f32_16x16x32_bf16 v[44:47], v[72:75], v[164:167], v[44:47]
    v_and_b32 v239, 0xffff0000, v239
    s_nop 4
    v_cvt_pk_bf16_f32 v16, v16, v17
    v_and_b32 v17, 0xffff0000, v16
    v_lshlrev_b32 v16, 16, v16
    v_pk_add_f32 v[16:17], v[16:17], v[176:177]
    v_cvt_pk_bf16_f32 v16, v16, v17
    v_and_b32 v17, 0xffff0000, v16
    v_lshlrev_b32 v16, 16, v16
    v_pk_add_f32 v[16:17], v[16:17], v[208:209]
    v_cvt_pk_bf16_f32 v112, v16, v17
    v_cvt_pk_bf16_f32 v18, v18, v19
    v_and_b32 v19, 0xffff0000, v18
    v_lshlrev_b32 v18, 16, v18
    v_pk_add_f32 v[18:19], v[18:19], v[178:179]
    v_cvt_pk_bf16_f32 v18, v18, v19
    v_and_b32 v19, 0xffff0000, v18
    v_lshlrev_b32 v18, 16, v18
    v_pk_add_f32 v[18:19], v[18:19], v[210:211]
    v_cvt_pk_bf16_f32 v113, v18, v19
    buffer_store_dwordx2 v[112:113], v175, s[36:39], s55 offen sc1
    s_add_u32 s55, s55, 327680
    v_cvt_pk_bf16_f32 v20, v20, v21
    v_and_b32 v21, 0xffff0000, v20
    v_lshlrev_b32 v20, 16, v20
    v_pk_add_f32 v[20:21], v[20:21], v[180:181]
    v_cvt_pk_bf16_f32 v20, v20, v21
    v_and_b32 v21, 0xffff0000, v20
    v_lshlrev_b32 v20, 16, v20
    v_pk_add_f32 v[20:21], v[20:21], v[212:213]
    v_cvt_pk_bf16_f32 v114, v20, v21
    v_cvt_pk_bf16_f32 v22, v22, v23
    v_and_b32 v23, 0xffff0000, v22
    v_lshlrev_b32 v22, 16, v22
    v_pk_add_f32 v[22:23], v[22:23], v[182:183]
    v_cvt_pk_bf16_f32 v22, v22, v23
    v_and_b32 v23, 0xffff0000, v22
    v_lshlrev_b32 v22, 16, v22
    v_pk_add_f32 v[22:23], v[22:23], v[214:215]
    v_cvt_pk_bf16_f32 v115, v22, v23
    buffer_store_dwordx2 v[114:115], v175, s[36:39], s55 offen sc1
    s_add_u32 s55, s55, 327680
    v_cvt_pk_bf16_f32 v24, v24, v25
    v_and_b32 v25, 0xffff0000, v24
    v_lshlrev_b32 v24, 16, v24
    v_pk_add_f32 v[24:25], v[24:25], v[184:185]
    v_cvt_pk_bf16_f32 v24, v24, v25
    v_and_b32 v25, 0xffff0000, v24
    v_lshlrev_b32 v24, 16, v24
    v_pk_add_f32 v[24:25], v[24:25], v[216:217]
    v_cvt_pk_bf16_f32 v116, v24, v25
    v_cvt_pk_bf16_f32 v26, v26, v27
    v_and_b32 v27, 0xffff0000, v26
    v_lshlrev_b32 v26, 16, v26
    v_pk_add_f32 v[26:27], v[26:27], v[186:187]
    v_cvt_pk_bf16_f32 v26, v26, v27
    v_and_b32 v27, 0xffff0000, v26
    v_lshlrev_b32 v26, 16, v26
    v_pk_add_f32 v[26:27], v[26:27], v[218:219]
    v_cvt_pk_bf16_f32 v117, v26, v27
    buffer_store_dwordx2 v[116:117], v175, s[36:39], s55 offen sc1
    s_add_u32 s55, s55, 327680
    v_cvt_pk_bf16_f32 v28, v28, v29
    v_and_b32 v29, 0xffff0000, v28
    v_lshlrev_b32 v28, 16, v28
    v_pk_add_f32 v[28:29], v[28:29], v[188:189]
    v_cvt_pk_bf16_f32 v28, v28, v29
    v_and_b32 v29, 0xffff0000, v28
    v_lshlrev_b32 v28, 16, v28
    v_pk_add_f32 v[28:29], v[28:29], v[220:221]
    v_cvt_pk_bf16_f32 v118, v28, v29
    v_cvt_pk_bf16_f32 v30, v30, v31
    v_and_b32 v31, 0xffff0000, v30
    v_lshlrev_b32 v30, 16, v30
    v_pk_add_f32 v[30:31], v[30:31], v[190:191]
    v_cvt_pk_bf16_f32 v30, v30, v31
    v_and_b32 v31, 0xffff0000, v30
    v_lshlrev_b32 v30, 16, v30
    v_pk_add_f32 v[30:31], v[30:31], v[222:223]
    v_cvt_pk_bf16_f32 v119, v30, v31
    buffer_store_dwordx2 v[118:119], v175, s[36:39], s55 offen sc1
    s_add_u32 s55, s55, 327680
    v_cvt_pk_bf16_f32 v32, v32, v33
    v_and_b32 v33, 0xffff0000, v32
    v_lshlrev_b32 v32, 16, v32
    v_pk_add_f32 v[32:33], v[32:33], v[192:193]
    v_cvt_pk_bf16_f32 v32, v32, v33
    v_and_b32 v33, 0xffff0000, v32
    v_lshlrev_b32 v32, 16, v32
    v_pk_add_f32 v[32:33], v[32:33], v[224:225]
    v_cvt_pk_bf16_f32 v120, v32, v33
    v_cvt_pk_bf16_f32 v34, v34, v35
    v_and_b32 v35, 0xffff0000, v34
    v_lshlrev_b32 v34, 16, v34
    v_pk_add_f32 v[34:35], v[34:35], v[194:195]
    v_cvt_pk_bf16_f32 v34, v34, v35
    v_and_b32 v35, 0xffff0000, v34
    v_lshlrev_b32 v34, 16, v34
    v_pk_add_f32 v[34:35], v[34:35], v[226:227]
    v_cvt_pk_bf16_f32 v121, v34, v35
    buffer_store_dwordx2 v[120:121], v175, s[36:39], s55 offen sc1
    s_add_u32 s55, s55, 327680
    v_cvt_pk_bf16_f32 v36, v36, v37
    v_and_b32 v37, 0xffff0000, v36
    v_lshlrev_b32 v36, 16, v36
    v_pk_add_f32 v[36:37], v[36:37], v[196:197]
    v_cvt_pk_bf16_f32 v36, v36, v37
    v_and_b32 v37, 0xffff0000, v36
    v_lshlrev_b32 v36, 16, v36
    v_pk_add_f32 v[36:37], v[36:37], v[228:229]
    v_cvt_pk_bf16_f32 v122, v36, v37
    v_cvt_pk_bf16_f32 v38, v38, v39
    v_and_b32 v39, 0xffff0000, v38
    v_lshlrev_b32 v38, 16, v38
    v_pk_add_f32 v[38:39], v[38:39], v[198:199]
    v_cvt_pk_bf16_f32 v38, v38, v39
    v_and_b32 v39, 0xffff0000, v38
    v_lshlrev_b32 v38, 16, v38
    v_pk_add_f32 v[38:39], v[38:39], v[230:231]
    v_cvt_pk_bf16_f32 v123, v38, v39
    buffer_store_dwordx2 v[122:123], v175, s[36:39], s55 offen sc1
    s_add_u32 s55, s55, 327680
    v_cvt_pk_bf16_f32 v40, v40, v41
    v_and_b32 v41, 0xffff0000, v40
    v_lshlrev_b32 v40, 16, v40
    v_pk_add_f32 v[40:41], v[40:41], v[200:201]
    v_cvt_pk_bf16_f32 v40, v40, v41
    v_and_b32 v41, 0xffff0000, v40
    v_lshlrev_b32 v40, 16, v40
    v_pk_add_f32 v[40:41], v[40:41], v[232:233]
    v_cvt_pk_bf16_f32 v124, v40, v41
    v_cvt_pk_bf16_f32 v42, v42, v43
    v_and_b32 v43, 0xffff0000, v42
    v_lshlrev_b32 v42, 16, v42
    v_pk_add_f32 v[42:43], v[42:43], v[202:203]
    v_cvt_pk_bf16_f32 v42, v42, v43
    v_and_b32 v43, 0xffff0000, v42
    v_lshlrev_b32 v42, 16, v42
    v_pk_add_f32 v[42:43], v[42:43], v[234:235]
    v_cvt_pk_bf16_f32 v125, v42, v43
    buffer_store_dwordx2 v[124:125], v175, s[36:39], s55 offen sc1
    s_add_u32 s55, s55, 327680
    v_cvt_pk_bf16_f32 v44, v44, v45
    v_and_b32 v45, 0xffff0000, v44
    v_lshlrev_b32 v44, 16, v44
    v_pk_add_f32 v[44:45], v[44:45], v[204:205]
    v_cvt_pk_bf16_f32 v44, v44, v45
    v_and_b32 v45, 0xffff0000, v44
    v_lshlrev_b32 v44, 16, v44
    v_pk_add_f32 v[44:45], v[44:45], v[236:237]
    v_cvt_pk_bf16_f32 v126, v44, v45
    v_cvt_pk_bf16_f32 v46, v46, v47
    v_and_b32 v47, 0xffff0000, v46
    v_lshlrev_b32 v46, 16, v46
    v_pk_add_f32 v[46:47], v[46:47], v[206:207]
    v_cvt_pk_bf16_f32 v46, v46, v47
    v_and_b32 v47, 0xffff0000, v46
    v_lshlrev_b32 v46, 16, v46
    v_pk_add_f32 v[46:47], v[46:47], v[238:239]
    v_cvt_pk_bf16_f32 v127, v46, v47
    buffer_store_dwordx2 v[126:127], v175, s[36:39], s55 offen sc1
    s_add_u32 s55, s55, 327680
    s_waitcnt vmcnt(0)
    v_mov_b32 v120, 163824
    v_mov_b32 v121, 1
    s_mov_b64 exec, 1
    ds_add_rtn_u32 v121, v120, v121
    s_mov_b64 exec, -1
    s_waitcnt lgkmcnt(0)
    v_readfirstlane_b32 s85, v121
    s_nop 3
    s_cmp_lg_u32 s85, 3
    s_cbranch_scc1 L_notlast_1
    s_mul_i32 s85, s2, 128
    s_add_u32 s85, s85, 32768
    v_mov_b32 v120, s3
    v_mov_b32 v121, s85
    s_mov_b64 exec, 1
    buffer_store_dword v120, v121, s[92:95], 0 offen sc1
    s_mov_b64 exec, -1
L_notlast_1:
    s_branch L_mfma
L_partner:
    s_mul_i32 s53, s7, 27776
    s_mul_i32 s55, s7, 3072
    s_add_u32 s55, s55, 145408
    v_lshlrev_b32 v7, 4, v1
    v_add_u32 v5, s55, v7
    v_mov_b32 v20, 0
    v_mov_b32 v21, 0
    v_mov_b32 v22, 0
    v_mov_b32 v23, 0
    v_add_u32 v9, s53, v7
    v_lshrrev_b32 v16, 1, v1
    v_mul_u32_u24 v16, 1344, v16
    v_and_b32 v17, 1, v1
    v_lshl_add_u32 v16, v17, 4, v16
    v_add_u32 v16, 1216, v16
    v_mov_b32 v17, 17408
    v_cmp_eq_u32 vcc, 8, v1
    s_nop 1
    v_cndmask_b32 v16, v16, v17, vcc
    v_mov_b32 v17, 20512
    v_cmp_eq_u32 vcc, 9, v1
    s_nop 1
    v_cndmask_b32 v16, v16, v17, vcc
    v_mov_b32 v17, 23616
    v_cmp_eq_u32 vcc, 10, v1
    s_nop 1
    v_cndmask_b32 v16, v16, v17, vcc
    v_mov_b32 v17, 25696
    v_cmp_eq_u32 vcc, 11, v1
    s_nop 1
    v_cndmask_b32 v16, v16, v17, vcc
    v_mov_b32 v17, 20496
    v_cmp_eq_u32 vcc, 12, v1
    s_nop 1
    v_cndmask_b32 v16, v16, v17, vcc
    v_mov_b32 v17, 23600
    v_cmp_eq_u32 vcc, 13, v1
    s_nop 1
    v_cndmask_b32 v16, v16, v17, vcc
    v_mov_b32 v17, 25680
    v_cmp_eq_u32 vcc, 14, v1
    s_nop 1
    v_cndmask_b32 v16, v16, v17, vcc
    v_mov_b32 v17, 27760
    v_cmp_eq_u32 vcc, 15, v1
    s_nop 1
    v_cndmask_b32 v16, v16, v17, vcc
    v_add_u32 v16, s53, v16
    ds_write_b128 v5, v[80:83] offset:0
    ds_write_b128 v5, v[84:87] offset:1024
    ds_write_b128 v5, v[88:91] offset:2048
    s_add_u32 s32, s4, 0x400000
    s_addc_u32 s33, s5, 0
    s_mov_b32 s34, 2621440
    s_mov_b32 s35, 0x20000
    s_add_u32 s36, s4, 0x1700000
    s_addc_u32 s37, s5, 0
    s_mov_b32 s38, 16384
    s_mov_b32 s39, 0x20000
    s_lshl_b32 s54, s2, 8
    s_mul_i32 s61, s7, 655360
    s_add_u32 s54, s54, s61
    s_lshl_b32 s61, s7, 11
    s_add_u32 s62, s61, 8192
    v_lshrrev_b32 v8, 2, v1
    v_mul_u32_u24 v8, 40960, v8
    v_and_b32 v14, 3, v1
    v_lshl_add_u32 v8, v14, 4, v8
    v_lshlrev_b32 v14, 5, v1
    s_lshl_b32 s63, s7, 10
    v_add_u32 v15, s63, v7
    s_waitcnt lgkmcnt(0)
    s_barrier
    s_mov_b64 exec, 0x3fffffff
    ds_write_b128 v9, v[20:23] offset:8704
    s_mov_b64 exec, 0xffff
    ds_write_b128 v16, v[20:23]
    s_mov_b64 exec, -1
    s_mul_i32 s60, s7, 2048
    v_add_u32 v24, 0, v1
    v_min_u32 v24, 15, v24
    v_mul_u32_u24 v24, 128, v24
    s_add_u32 s86, s60, 4096
    s_mov_b32 s84, 0
L_poll_2:
    buffer_load_dword v25, v24, s[92:95], s86 offen sc1
    s_waitcnt vmcnt(0)
    v_xor_b32 v25, s3, v25
    v_cmp_ne_u32 vcc, 0, v25
    s_cbranch_vccz L_polld_3
    s_sleep 3
    s_add_u32 s84, s84, 1
    s_cmp_lt_u32 s84, 400000
    s_cbranch_scc1 L_poll_2
L_polld_3:
    buffer_load_dwordx4 v[48:51], v14, s[36:39], s61 offen offset:0 sc1
    buffer_load_dwordx4 v[56:59], v14, s[36:39], s62 offen offset:0 sc1
    buffer_load_dwordx4 v[52:55], v14, s[36:39], s61 offen offset:16 sc1
    buffer_load_dwordx4 v[60:63], v14, s[36:39], s62 offen offset:16 sc1
    buffer_load_dwordx4 v[32:35], v8, s[32:35], s54 offen offset:0 sc1
    buffer_load_dwordx4 v[36:39], v8, s[32:35], s54 offen offset:64 sc1
    buffer_load_dwordx4 v[40:43], v8, s[32:35], s54 offen offset:128 sc1
    buffer_load_dwordx4 v[44:47], v8, s[32:35], s54 offen offset:192 sc1
    s_waitcnt vmcnt(3)
    v_lshlrev_b32 v80, 16, v32
    v_and_b32 v81, 0xffff0000, v32
    v_pk_add_f32 v[80:81], v[80:81], v[48:49]
    v_cvt_pk_bf16_f32 v80, v80, v81
    v_and_b32 v81, 0xffff0000, v80
    v_lshlrev_b32 v80, 16, v80
    v_pk_mul_f32 v[80:81], v[80:81], v[56:57]
    v_cvt_pk_bf16_f32 v64, v80, v81
    v_lshlrev_b32 v82, 16, v33
    v_and_b32 v83, 0xffff0000, v33
    v_pk_add_f32 v[82:83], v[82:83], v[50:51]
    v_cvt_pk_bf16_f32 v82, v82, v83
    v_and_b32 v83, 0xffff0000, v82
    v_lshlrev_b32 v82, 16, v82
    v_pk_mul_f32 v[82:83], v[82:83], v[58:59]
    v_cvt_pk_bf16_f32 v65, v82, v83
    v_lshlrev_b32 v84, 16, v34
    v_and_b32 v85, 0xffff0000, v34
    v_pk_add_f32 v[84:85], v[84:85], v[52:53]
    v_cvt_pk_bf16_f32 v84, v84, v85
    v_and_b32 v85, 0xffff0000, v84
    v_lshlrev_b32 v84, 16, v84
    v_pk_mul_f32 v[84:85], v[84:85], v[60:61]
    v_cvt_pk_bf16_f32 v66, v84, v85
    v_lshlrev_b32 v86, 16, v35
    v_and_b32 v87, 0xffff0000, v35
    v_pk_add_f32 v[86:87], v[86:87], v[54:55]
    v_cvt_pk_bf16_f32 v86, v86, v87
    v_and_b32 v87, 0xffff0000, v86
    v_lshlrev_b32 v86, 16, v86
    v_pk_mul_f32 v[86:87], v[86:87], v[62:63]
    v_cvt_pk_bf16_f32 v67, v86, v87
    ds_write_b128 v15, v[64:67] offset:9184
    ds_write_b128 v15, v[32:35] offset:13312
    s_waitcnt vmcnt(2)
    v_lshlrev_b32 v80, 16, v36
    v_and_b32 v81, 0xffff0000, v36
    v_pk_add_f32 v[80:81], v[80:81], v[48:49]
    v_cvt_pk_bf16_f32 v80, v80, v81
    v_and_b32 v81, 0xffff0000, v80
    v_lshlrev_b32 v80, 16, v80
    v_pk_mul_f32 v[80:81], v[80:81], v[56:57]
    v_cvt_pk_bf16_f32 v68, v80, v81
    v_lshlrev_b32 v82, 16, v37
    v_and_b32 v83, 0xffff0000, v37
    v_pk_add_f32 v[82:83], v[82:83], v[50:51]
    v_cvt_pk_bf16_f32 v82, v82, v83
    v_and_b32 v83, 0xffff0000, v82
    v_lshlrev_b32 v82, 16, v82
    v_pk_mul_f32 v[82:83], v[82:83], v[58:59]
    v_cvt_pk_bf16_f32 v69, v82, v83
    v_lshlrev_b32 v84, 16, v38
    v_and_b32 v85, 0xffff0000, v38
    v_pk_add_f32 v[84:85], v[84:85], v[52:53]
    v_cvt_pk_bf16_f32 v84, v84, v85
    v_and_b32 v85, 0xffff0000, v84
    v_lshlrev_b32 v84, 16, v84
    v_pk_mul_f32 v[84:85], v[84:85], v[60:61]
    v_cvt_pk_bf16_f32 v70, v84, v85
    v_lshlrev_b32 v86, 16, v39
    v_and_b32 v87, 0xffff0000, v39
    v_pk_add_f32 v[86:87], v[86:87], v[54:55]
    v_cvt_pk_bf16_f32 v86, v86, v87
    v_and_b32 v87, 0xffff0000, v86
    v_lshlrev_b32 v86, 16, v86
    v_pk_mul_f32 v[86:87], v[86:87], v[62:63]
    v_cvt_pk_bf16_f32 v71, v86, v87
    ds_write_b128 v15, v[68:71] offset:36960
    ds_write_b128 v15, v[36:39] offset:41088
    s_waitcnt vmcnt(1)
    v_lshlrev_b32 v80, 16, v40
    v_and_b32 v81, 0xffff0000, v40
    v_pk_add_f32 v[80:81], v[80:81], v[48:49]
    v_cvt_pk_bf16_f32 v80, v80, v81
    v_and_b32 v81, 0xffff0000, v80
    v_lshlrev_b32 v80, 16, v80
    v_pk_mul_f32 v[80:81], v[80:81], v[56:57]
    v_cvt_pk_bf16_f32 v72, v80, v81
    v_lshlrev_b32 v82, 16, v41
    v_and_b32 v83, 0xffff0000, v41
    v_pk_add_f32 v[82:83], v[82:83], v[50:51]
    v_cvt_pk_bf16_f32 v82, v82, v83
    v_and_b32 v83, 0xffff0000, v82
    v_lshlrev_b32 v82, 16, v82
    v_pk_mul_f32 v[82:83], v[82:83], v[58:59]
    v_cvt_pk_bf16_f32 v73, v82, v83
    v_lshlrev_b32 v84, 16, v42
    v_and_b32 v85, 0xffff0000, v42
    v_pk_add_f32 v[84:85], v[84:85], v[52:53]
    v_cvt_pk_bf16_f32 v84, v84, v85
    v_and_b32 v85, 0xffff0000, v84
    v_lshlrev_b32 v84, 16, v84
    v_pk_mul_f32 v[84:85], v[84:85], v[60:61]
    v_cvt_pk_bf16_f32 v74, v84, v85
    v_lshlrev_b32 v86, 16, v43
    v_and_b32 v87, 0xffff0000, v43
    v_pk_add_f32 v[86:87], v[86:87], v[54:55]
    v_cvt_pk_bf16_f32 v86, v86, v87
    v_and_b32 v87, 0xffff0000, v86
    v_lshlrev_b32 v86, 16, v86
    v_pk_mul_f32 v[86:87], v[86:87], v[62:63]
    v_cvt_pk_bf16_f32 v75, v86, v87
    v_add_u32 v15, 55552, v15
    ds_write_b128 v15, v[72:75] offset:9184
    ds_write_b128 v15, v[40:43] offset:13312
    s_waitcnt vmcnt(0)
    v_lshlrev_b32 v80, 16, v44
    v_and_b32 v81, 0xffff0000, v44
    v_pk_add_f32 v[80:81], v[80:81], v[48:49]
    v_cvt_pk_bf16_f32 v80, v80, v81
    v_and_b32 v81, 0xffff0000, v80
    v_lshlrev_b32 v80, 16, v80
    v_pk_mul_f32 v[80:81], v[80:81], v[56:57]
    v_cvt_pk_bf16_f32 v76, v80, v81
    v_lshlrev_b32 v82, 16, v45
    v_and_b32 v83, 0xffff0000, v45
    v_pk_add_f32 v[82:83], v[82:83], v[50:51]
    v_cvt_pk_bf16_f32 v82, v82, v83
    v_and_b32 v83, 0xffff0000, v82
    v_lshlrev_b32 v82, 16, v82
    v_pk_mul_f32 v[82:83], v[82:83], v[58:59]
    v_cvt_pk_bf16_f32 v77, v82, v83
    v_lshlrev_b32 v84, 16, v46
    v_and_b32 v85, 0xffff0000, v46
    v_pk_add_f32 v[84:85], v[84:85], v[52:53]
    v_cvt_pk_bf16_f32 v84, v84, v85
    v_and_b32 v85, 0xffff0000, v84
    v_lshlrev_b32 v84, 16, v84
    v_pk_mul_f32 v[84:85], v[84:85], v[60:61]
    v_cvt_pk_bf16_f32 v78, v84, v85
    v_lshlrev_b32 v86, 16, v47
    v_and_b32 v87, 0xffff0000, v47
    v_pk_add_f32 v[86:87], v[86:87], v[54:55]
    v_cvt_pk_bf16_f32 v86, v86, v87
    v_and_b32 v87, 0xffff0000, v86
    v_lshlrev_b32 v86, 16, v86
    v_pk_mul_f32 v[86:87], v[86:87], v[62:63]
    v_cvt_pk_bf16_f32 v79, v86, v87
    ds_write_b128 v15, v[76:79] offset:36960
    ds_write_b128 v15, v[44:47] offset:41088
    s_waitcnt lgkmcnt(0)
    s_barrier
    ds_read_b64 v[32:33], v9 offset:9160
    ds_read_b128 v[34:37], v9 offset:9168
    ds_read_b64 v[38:39], v9 offset:9184
    ds_read_b64 v[40:41], v9 offset:10184
    ds_read_b128 v[42:45], v9 offset:10192
    ds_read_b64 v[46:47], v9 offset:10208
    ds_read_b64 v[48:49], v9 offset:11208
    ds_read_b128 v[50:53], v9 offset:11216
    ds_read_b64 v[54:55], v9 offset:11232
    s_waitcnt lgkmcnt(6)
    v_lshlrev_b32 v64, 16, v32
    v_and_b32 v65, 0xffff0000, v32
    v_lshlrev_b32 v66, 16, v33
    v_and_b32 v67, 0xffff0000, v33
    v_lshlrev_b32 v68, 16, v34
    v_and_b32 v69, 0xffff0000, v34
    v_lshlrev_b32 v70, 16, v35
    v_and_b32 v71, 0xffff0000, v35
    v_lshlrev_b32 v72, 16, v36
    v_and_b32 v73, 0xffff0000, v36
    v_lshlrev_b32 v74, 16, v37
    v_and_b32 v75, 0xffff0000, v37
    v_lshlrev_b32 v76, 16, v38
    v_and_b32 v77, 0xffff0000, v38
    v_lshlrev_b32 v78, 16, v39
    v_and_b32 v79, 0xffff0000, v39
    v_add_f32 v88, v67, v69
    v_add_f32 v89, v68, v70
    v_add_f32 v90, v69, v71
    v_add_f32 v91, v70, v72
    v_add_f32 v92, v71, v73
    v_add_f32 v93, v72, v74
    v_add_f32 v94, v73, v75
    v_add_f32 v95, v74, v76
    v_pk_add_f32 v[80:81], v[88:89], v[68:69]
    v_pk_add_f32 v[82:83], v[90:91], v[70:71]
    v_pk_add_f32 v[84:85], v[92:93], v[72:73]
    v_pk_add_f32 v[86:87], v[94:95], v[74:75]
    v_cvt_pk_bf16_f32 v96, v80, v81
    v_cvt_pk_bf16_f32 v97, v82, v83
    v_cvt_pk_bf16_f32 v98, v84, v85
    v_cvt_pk_bf16_f32 v99, v86, v87
    ds_write_b128 v9, v[96:99] offset:17424
    v_pk_add_f32 v[88:89], v[66:67], v[70:71]
    v_pk_add_f32 v[90:91], v[68:69], v[72:73]
    v_pk_add_f32 v[92:93], v[70:71], v[74:75]
    v_pk_add_f32 v[94:95], v[72:73], v[76:77]
    v_pk_add_f32 v[80:81], v[88:89], v[80:81]
    v_pk_add_f32 v[82:83], v[90:91], v[82:83]
    v_pk_add_f32 v[84:85], v[92:93], v[84:85]
    v_pk_add_f32 v[86:87], v[94:95], v[86:87]
    v_cvt_pk_bf16_f32 v100, v80, v81
    v_cvt_pk_bf16_f32 v101, v82, v83
    v_cvt_pk_bf16_f32 v102, v84, v85
    v_cvt_pk_bf16_f32 v103, v86, v87
    ds_write_b128 v9, v[100:103] offset:20528
    v_add_f32 v88, v65, v71
    v_add_f32 v89, v66, v72
    v_add_f32 v90, v67, v73
    v_add_f32 v91, v68, v74
    v_add_f32 v92, v69, v75
    v_add_f32 v93, v70, v76
    v_add_f32 v94, v71, v77
    v_add_f32 v95, v72, v78
    v_pk_add_f32 v[80:81], v[88:89], v[80:81]
    v_pk_add_f32 v[82:83], v[90:91], v[82:83]
    v_pk_add_f32 v[84:85], v[92:93], v[84:85]
    v_pk_add_f32 v[86:87], v[94:95], v[86:87]
    v_cvt_pk_bf16_f32 v104, v80, v81
    v_cvt_pk_bf16_f32 v105, v82, v83
    v_cvt_pk_bf16_f32 v106, v84, v85
    v_cvt_pk_bf16_f32 v107, v86, v87
    ds_write_b128 v9, v[104:107] offset:23632
    v_pk_add_f32 v[88:89], v[64:65], v[72:73]
    v_pk_add_f32 v[90:91], v[66:67], v[74:75]
    v_pk_add_f32 v[92:93], v[68:69], v[76:77]
    v_pk_add_f32 v[94:95], v[70:71], v[78:79]
    v_pk_add_f32 v[80:81], v[88:89], v[80:81]
    v_pk_add_f32 v[82:83], v[90:91], v[82:83]
    v_pk_add_f32 v[84:85], v[92:93], v[84:85]
    v_pk_add_f32 v[86:87], v[94:95], v[86:87]
    v_cvt_pk_bf16_f32 v108, v80, v81
    v_cvt_pk_bf16_f32 v109, v82, v83
    v_cvt_pk_bf16_f32 v110, v84, v85
    v_cvt_pk_bf16_f32 v111, v86, v87
    ds_write_b128 v9, v[108:111] offset:25712
    s_waitcnt lgkmcnt(7)
    v_lshlrev_b32 v64, 16, v40
    v_and_b32 v65, 0xffff0000, v40
    v_lshlrev_b32 v66, 16, v41
    v_and_b32 v67, 0xffff0000, v41
    v_lshlrev_b32 v68, 16, v42
    v_and_b32 v69, 0xffff0000, v42
    v_lshlrev_b32 v70, 16, v43
    v_and_b32 v71, 0xffff0000, v43
    v_lshlrev_b32 v72, 16, v44
    v_and_b32 v73, 0xffff0000, v44
    v_lshlrev_b32 v74, 16, v45
    v_and_b32 v75, 0xffff0000, v45
    v_lshlrev_b32 v76, 16, v46
    v_and_b32 v77, 0xffff0000, v46
    v_lshlrev_b32 v78, 16, v47
    v_and_b32 v79, 0xffff0000, v47
    v_add_f32 v88, v67, v69
    v_add_f32 v89, v68, v70
    v_add_f32 v90, v69, v71
    v_add_f32 v91, v70, v72
    v_add_f32 v92, v71, v73
    v_add_f32 v93, v72, v74
    v_add_f32 v94, v73, v75
    v_add_f32 v95, v74, v76
    v_pk_add_f32 v[80:81], v[88:89], v[68:69]
    v_pk_add_f32 v[82:83], v[90:91], v[70:71]
    v_pk_add_f32 v[84:85], v[92:93], v[72:73]
    v_pk_add_f32 v[86:87], v[94:95], v[74:75]
    v_cvt_pk_bf16_f32 v96, v80, v81
    v_cvt_pk_bf16_f32 v97, v82, v83
    v_cvt_pk_bf16_f32 v98, v84, v85
    v_cvt_pk_bf16_f32 v99, v86, v87
    ds_write_b128 v9, v[96:99] offset:18448
    v_pk_add_f32 v[88:89], v[66:67], v[70:71]
    v_pk_add_f32 v[90:91], v[68:69], v[72:73]
    v_pk_add_f32 v[92:93], v[70:71], v[74:75]
    v_pk_add_f32 v[94:95], v[72:73], v[76:77]
    v_pk_add_f32 v[80:81], v[88:89], v[80:81]
    v_pk_add_f32 v[82:83], v[90:91], v[82:83]
    v_pk_add_f32 v[84:85], v[92:93], v[84:85]
    v_pk_add_f32 v[86:87], v[94:95], v[86:87]
    v_cvt_pk_bf16_f32 v100, v80, v81
    v_cvt_pk_bf16_f32 v101, v82, v83
    v_cvt_pk_bf16_f32 v102, v84, v85
    v_cvt_pk_bf16_f32 v103, v86, v87
    ds_write_b128 v9, v[100:103] offset:21552
    v_add_f32 v88, v65, v71
    v_add_f32 v89, v66, v72
    v_add_f32 v90, v67, v73
    v_add_f32 v91, v68, v74
    v_add_f32 v92, v69, v75
    v_add_f32 v93, v70, v76
    v_add_f32 v94, v71, v77
    v_add_f32 v95, v72, v78
    v_pk_add_f32 v[80:81], v[88:89], v[80:81]
    v_pk_add_f32 v[82:83], v[90:91], v[82:83]
    v_pk_add_f32 v[84:85], v[92:93], v[84:85]
    v_pk_add_f32 v[86:87], v[94:95], v[86:87]
    v_cvt_pk_bf16_f32 v104, v80, v81
    v_cvt_pk_bf16_f32 v105, v82, v83
    v_cvt_pk_bf16_f32 v106, v84, v85
    v_cvt_pk_bf16_f32 v107, v86, v87
    ds_write_b128 v9, v[104:107] offset:24656
    v_pk_add_f32 v[88:89], v[64:65], v[72:73]
    v_pk_add_f32 v[90:91], v[66:67], v[74:75]
    v_pk_add_f32 v[92:93], v[68:69], v[76:77]
    v_pk_add_f32 v[94:95], v[70:71], v[78:79]
    v_pk_add_f32 v[80:81], v[88:89], v[80:81]
    v_pk_add_f32 v[82:83], v[90:91], v[82:83]
    v_pk_add_f32 v[84:85], v[92:93], v[84:85]
    v_pk_add_f32 v[86:87], v[94:95], v[86:87]
    v_cvt_pk_bf16_f32 v108, v80, v81
    v_cvt_pk_bf16_f32 v109, v82, v83
    v_cvt_pk_bf16_f32 v110, v84, v85
    v_cvt_pk_bf16_f32 v111, v86, v87
    ds_write_b128 v9, v[108:111] offset:26736
    s_waitcnt lgkmcnt(8)
    v_lshlrev_b32 v64, 16, v48
    v_and_b32 v65, 0xffff0000, v48
    v_lshlrev_b32 v66, 16, v49
    v_and_b32 v67, 0xffff0000, v49
    v_lshlrev_b32 v68, 16, v50
    v_and_b32 v69, 0xffff0000, v50
    v_lshlrev_b32 v70, 16, v51
    v_and_b32 v71, 0xffff0000, v51
    v_lshlrev_b32 v72, 16, v52
    v_and_b32 v73, 0xffff0000, v52
    v_lshlrev_b32 v74, 16, v53
    v_and_b32 v75, 0xffff0000, v53
    v_lshlrev_b32 v76, 16, v54
    v_and_b32 v77, 0xffff0000, v54
    v_lshlrev_b32 v78, 16, v55
    v_and_b32 v79, 0xffff0000, v55
    v_add_f32 v88, v67, v69
    v_add_f32 v89, v68, v70
    v_add_f32 v90, v69, v71
    v_add_f32 v91, v70, v72
    v_add_f32 v92, v71, v73
    v_add_f32 v93, v72, v74
    v_add_f32 v94, v73, v75
    v_add_f32 v95, v74, v76
    v_pk_add_f32 v[80:81], v[88:89], v[68:69]
    v_pk_add_f32 v[82:83], v[90:91], v[70:71]
    v_pk_add_f32 v[84:85], v[92:93], v[72:73]
    v_pk_add_f32 v[86:87], v[94:95], v[74:75]
    v_cvt_pk_bf16_f32 v96, v80, v81
    v_cvt_pk_bf16_f32 v97, v82, v83
    v_cvt_pk_bf16_f32 v98, v84, v85
    v_cvt_pk_bf16_f32 v99, v86, v87
    ds_write_b128 v9, v[96:99] offset:19472
    v_pk_add_f32 v[88:89], v[66:67], v[70:71]
    v_pk_add_f32 v[90:91], v[68:69], v[72:73]
    v_pk_add_f32 v[92:93], v[70:71], v[74:75]
    v_pk_add_f32 v[94:95], v[72:73], v[76:77]
    v_pk_add_f32 v[80:81], v[88:89], v[80:81]
    v_pk_add_f32 v[82:83], v[90:91], v[82:83]
    v_pk_add_f32 v[84:85], v[92:93], v[84:85]
    v_pk_add_f32 v[86:87], v[94:95], v[86:87]
    v_cvt_pk_bf16_f32 v100, v80, v81
    v_cvt_pk_bf16_f32 v101, v82, v83
    v_cvt_pk_bf16_f32 v102, v84, v85
    v_cvt_pk_bf16_f32 v103, v86, v87
    ds_write_b128 v9, v[100:103] offset:22576
    s_waitcnt lgkmcnt(0)
    s_barrier
    s_branch L_loader
L_aux:
    s_cmp_ge_u32 s2, 224
    s_cbranch_scc1 L_aux_rp
    s_sub_u32 s52, s2, 160
    v_lshl_add_u32 v5, v2, 2, v3
    s_mul_i32 s53, s52, 40960
    v_mul_u32_u24 v6, 1280, v5
    v_lshl_add_u32 v6, v4, 4, v6
    v_add_u32 v6, s53, v6
    s_mov_b32 s32, s8
    s_mov_b32 s33, s9
    s_mov_b32 s34, 2621440
    s_mov_b32 s35, 0x20000
    buffer_load_dwordx4 v[16:19], v6, s[32:35], 0 offen offset:0
    buffer_load_dwordx4 v[20:23], v6, s[32:35], 0 offen offset:256
    buffer_load_dwordx4 v[24:27], v6, s[32:35], 0 offen offset:512
    buffer_load_dwordx4 v[28:31], v6, s[32:35], 0 offen offset:768
    buffer_load_dwordx4 v[32:35], v6, s[32:35], 0 offen offset:1024
    v_mul_u32_u24 v7, 1312, v5
    v_lshl_add_u32 v7, v4, 4, v7
    s_mov_b32 s54, 0x3f803f80
    s_add_u32 s36, s4, 0x1700000
    s_addc_u32 s37, s5, 0
    s_mov_b32 s38, 16384
    s_mov_b32 s39, 0x20000
    s_add_u32 s40, s4, 0x400000
    s_addc_u32 s41, s5, 0
    s_mov_b32 s42, 2621440
    s_mov_b32 s43, 0x20000
    v_bfe_u32 v8, v1, 2, 2
    v_lshl_add_u32 v8, v3, 3, v8
    v_mul_u32_u24 v8, 1312, v8
    v_and_b32 v9, 3, v1
    v_lshl_add_u32 v8, v9, 3, v8
    v_mul_u32_u24 v9, 160, v2
    v_add_u32 v8, v8, v9
    v_mul_u32_u24 v9, 80, v2
    v_add_u32 v9, v9, v4
    v_lshlrev_b32 v9, 6, v9
    v_lshl_add_u32 v9, v3, 4, v9
    s_mul_i32 s53, s52, 40960
    s_add_u32 s55, s53, 4096
    s_lshl_b32 s56, s52, 7
    v_lshlrev_b32 v10, 2, v5
    v_and_b32 v11, 1, v4
    v_lshl_add_u32 v10, v11, 7, v10
    v_add_u32 v10, 41984, v10
    v_mov_b32 v80, 0
    v_mov_b32 v81, 0
    v_mov_b32 v82, 0
    v_mov_b32 v83, 0
    v_cmp_eq_u32 s[58:59], 1, v11
    s_waitcnt lgkmcnt(0)
    s_add_u32 s3, s3, 1
    s_waitcnt vmcnt(4)
    ds_write_b128 v7, v[16:19] offset:0
    v_dot2c_f32_bf16 v80, s54, v16
    v_dot2c_f32_bf16 v82, v16, v16
    v_dot2c_f32_bf16 v81, s54, v17
    v_dot2c_f32_bf16 v83, v17, v17
    v_dot2c_f32_bf16 v80, s54, v18
    v_dot2c_f32_bf16 v82, v18, v18
    v_dot2c_f32_bf16 v81, s54, v19
    v_dot2c_f32_bf16 v83, v19, v19
    s_waitcnt vmcnt(3)
    ds_write_b128 v7, v[20:23] offset:256
    v_dot2c_f32_bf16 v80, s54, v20
    v_dot2c_f32_bf16 v82, v20, v20
    v_dot2c_f32_bf16 v81, s54, v21
    v_dot2c_f32_bf16 v83, v21, v21
    v_dot2c_f32_bf16 v80, s54, v22
    v_dot2c_f32_bf16 v82, v22, v22
    v_dot2c_f32_bf16 v81, s54, v23
    v_dot2c_f32_bf16 v83, v23, v23
    s_waitcnt vmcnt(2)
    ds_write_b128 v7, v[24:27] offset:512
    v_dot2c_f32_bf16 v80, s54, v24
    v_dot2c_f32_bf16 v82, v24, v24
    v_dot2c_f32_bf16 v81, s54, v25
    v_dot2c_f32_bf16 v83, v25, v25
    v_dot2c_f32_bf16 v80, s54, v26
    v_dot2c_f32_bf16 v82, v26, v26
    v_dot2c_f32_bf16 v81, s54, v27
    v_dot2c_f32_bf16 v83, v27, v27
    s_waitcnt vmcnt(1)
    ds_write_b128 v7, v[28:31] offset:768
    v_dot2c_f32_bf16 v80, s54, v28
    v_dot2c_f32_bf16 v82, v28, v28
    v_dot2c_f32_bf16 v81, s54, v29
    v_dot2c_f32_bf16 v83, v29, v29
    v_dot2c_f32_bf16 v80, s54, v30
    v_dot2c_f32_bf16 v82, v30, v30
    v_dot2c_f32_bf16 v81, s54, v31
    v_dot2c_f32_bf16 v83, v31, v31
    s_waitcnt vmcnt(0)
    ds_write_b128 v7, v[32:35] offset:1024
    v_dot2c_f32_bf16 v80, s54, v32
    v_dot2c_f32_bf16 v82, v32, v32
    v_dot2c_f32_bf16 v81, s54, v33
    v_dot2c_f32_bf16 v83, v33, v33
    v_dot2c_f32_bf16 v80, s54, v34
    v_dot2c_f32_bf16 v82, v34, v34
    v_dot2c_f32_bf16 v81, s54, v35
    v_dot2c_f32_bf16 v83, v35, v35
    s_waitcnt lgkmcnt(0)
    s_barrier
    ds_read_b64_tr_b16 v[56:57], v8 offset:0
    ds_read_b64_tr_b16 v[58:59], v8 offset:5248
    ds_read_b64_tr_b16 v[60:61], v8 offset:32
    ds_read_b64_tr_b16 v[62:63], v8 offset:5280
    ds_read_b64_tr_b16 v[64:65], v8 offset:64
    ds_read_b64_tr_b16 v[66:67], v8 offset:5312
    ds_read_b64_tr_b16 v[68:69], v8 offset:96
    ds_read_b64_tr_b16 v[70:71], v8 offset:5344
    ds_read_b64_tr_b16 v[72:73], v8 offset:128
    ds_read_b64_tr_b16 v[74:75], v8 offset:5376
    v_add_f32 v80, v80, v81
    v_add_f32 v82, v82, v83
    s_waitcnt lgkmcnt(8)
    buffer_store_dwordx4 v[56:59], v9, s[40:43], s53 offen offset:0 sc1
    s_waitcnt lgkmcnt(6)
    buffer_store_dwordx4 v[60:63], v9, s[40:43], s53 offen offset:1024 sc1
    s_waitcnt lgkmcnt(4)
    buffer_store_dwordx4 v[64:67], v9, s[40:43], s53 offen offset:2048 sc1
    s_waitcnt lgkmcnt(2)
    buffer_store_dwordx4 v[68:71], v9, s[40:43], s53 offen offset:3072 sc1
    s_waitcnt lgkmcnt(0)
    buffer_store_dwordx4 v[72:75], v9, s[40:43], s55 offen offset:0 sc1
    v_add_f32_dpp v80, v80, v80 row_ror:8 row_mask:0xf bank_mask:0xf
    v_add_f32_dpp v82, v82, v82 row_ror:8 row_mask:0xf bank_mask:0xf
    s_nop 0
    v_add_f32_dpp v80, v80, v80 row_ror:4 row_mask:0xf bank_mask:0xf
    v_add_f32_dpp v82, v82, v82 row_ror:4 row_mask:0xf bank_mask:0xf
    s_nop 0
    v_add_f32_dpp v80, v80, v80 row_ror:2 row_mask:0xf bank_mask:0xf
    v_add_f32_dpp v82, v82, v82 row_ror:2 row_mask:0xf bank_mask:0xf
    s_nop 0
    v_add_f32_dpp v80, v80, v80 row_ror:1 row_mask:0xf bank_mask:0xf
    v_add_f32_dpp v82, v82, v82 row_ror:1 row_mask:0xf bank_mask:0xf
    s_nop 0
    v_mul_f32 v80, 0x3acccccd, v80
    v_mul_f32 v82, 0x3acccccd, v82
    v_fma_f32 v82, -v80, v80, v82
    v_max_f32 v82, 0, v82
    v_cvt_pk_bf16_f32 v84, v80, v80
    v_lshlrev_b32 v84, 16, v84
    v_xor_b32 v84, 0x80000000, v84
    v_cvt_pk_bf16_f32 v88, v82, v82
    v_lshlrev_b32 v88, 16, v88
    v_add_f32 v88, 0x3727c5ac, v88
    v_cvt_pk_bf16_f32 v88, v88, v88
    v_lshlrev_b32 v88, 16, v88
    v_sqrt_f32 v88, v88
    s_nop 0
    v_cvt_pk_bf16_f32 v88, v88, v88
    v_lshlrev_b32 v88, 16, v88
    v_rcp_f32 v85, v88
    s_nop 0
    v_cndmask_b32 v84, v84, v85, s[58:59]
    ds_write_b32 v10, v84
    s_waitcnt lgkmcnt(0)
    s_barrier
    s_cmp_lg_u32 s6, 7
    s_cbranch_scc1 L_lnst_4
    v_lshlrev_b32 v10, 2, v1
    v_add_u32 v11, 41984, v10
    ds_read_b32 v12, v11
    v_lshrrev_b32 v11, 5, v1
    v_mul_u32_u24 v11, 8064, v11
    v_add_u32 v10, v10, v11
    s_waitcnt lgkmcnt(0)
    buffer_store_dword v12, v10, s[36:39], s56 offen sc1
L_lnst_4:
    s_waitcnt vmcnt(0)
    s_barrier
    s_cmp_lg_u32 s6, 7
    s_cbranch_scc1 L_lnp_5
    s_mul_i32 s85, s52, 128
    s_add_u32 s85, s85, 4096
    v_mov_b32 v10, s3
    v_mov_b32 v11, s85
    s_mov_b64 exec, 1
    buffer_store_dword v10, v11, s[92:95], 0 offen sc1
    s_mov_b64 exec, -1
L_lnp_5:
    s_cmp_ge_u32 s6, 5
    s_cbranch_scc1 L_lnrp_6
    s_mul_i32 s55, s52, 5
    s_add_u32 s55, s55, s6
    s_mul_i32 s56, s6, 12288
    s_add_u32 s56, s56, 49152
    s_mul_i32 s57, s55, 205
    s_lshr_b32 s57, s57, 12
    s_mul_i32 s58, s57, 20
    s_sub_u32 s58, s55, s58
    s_mov_b32 s44, s24
    s_mov_b32 s45, s25
    s_mov_b32 s46, 1966080
    s_mov_b32 s47, 0x20000
    s_mov_b32 s48, s26
    s_mov_b32 s49, s27
    s_mov_b32 s50, 1966080
    s_mov_b32 s51, 0x20000
    s_mul_i32 s57, s57, 192
    s_mul_i32 s58, s58, 98304
    s_add_u32 s57, s57, s58
    v_add_u32 v10, 0, v1
    v_mul_u32_u24 v11, 43691, v10
    v_lshrrev_b32 v11, 19, v11
    v_mul_u32_u24 v12, 12, v11
    v_sub_u32 v12, v10, v12
    v_mul_u32_u24 v11, 3072, v11
    v_lshl_add_u32 v13, v12, 4, v11
    s_add_u32 m0, s56, 0
    s_nop 0
    buffer_load_dwordx4 v13, s[44:47], s57 offen lds
    s_add_u32 m0, s56, 6144
    s_nop 0
    buffer_load_dwordx4 v13, s[48:51], s57 offen lds
    v_add_u32 v10, 64, v1
    v_mul_u32_u24 v11, 43691, v10
    v_lshrrev_b32 v11, 19, v11
    v_mul_u32_u24 v12, 12, v11
    v_sub_u32 v12, v10, v12
    v_mul_u32_u24 v11, 3072, v11
    v_lshl_add_u32 v13, v12, 4, v11
    s_add_u32 m0, s56, 1024
    s_nop 0
    buffer_load_dwordx4 v13, s[44:47], s57 offen lds
    s_add_u32 m0, s56, 7168
    s_nop 0
    buffer_load_dwordx4 v13, s[48:51], s57 offen lds
    v_add_u32 v10, 128, v1
    v_mul_u32_u24 v11, 43691, v10
    v_lshrrev_b32 v11, 19, v11
    v_mul_u32_u24 v12, 12, v11
    v_sub_u32 v12, v10, v12
    v_mul_u32_u24 v11, 3072, v11
    v_lshl_add_u32 v13, v12, 4, v11
    s_add_u32 m0, s56, 2048
    s_nop 0
    buffer_load_dwordx4 v13, s[44:47], s57 offen lds
    s_add_u32 m0, s56, 8192
    s_nop 0
    buffer_load_dwordx4 v13, s[48:51], s57 offen lds
    v_add_u32 v10, 192, v1
    v_mul_u32_u24 v11, 43691, v10
    v_lshrrev_b32 v11, 19, v11
    v_mul_u32_u24 v12, 12, v11
    v_sub_u32 v12, v10, v12
    v_mul_u32_u24 v11, 3072, v11
    v_lshl_add_u32 v13, v12, 4, v11
    s_add_u32 m0, s56, 3072
    s_nop 0
    buffer_load_dwordx4 v13, s[44:47], s57 offen lds
    s_add_u32 m0, s56, 9216
    s_nop 0
    buffer_load_dwordx4 v13, s[48:51], s57 offen lds
    v_add_u32 v10, 256, v1
    v_mul_u32_u24 v11, 43691, v10
    v_lshrrev_b32 v11, 19, v11
    v_mul_u32_u24 v12, 12, v11
    v_sub_u32 v12, v10, v12
    v_mul_u32_u24 v11, 3072, v11
    v_lshl_add_u32 v13, v12, 4, v11
    s_add_u32 m0, s56, 4096
    s_nop 0
    buffer_load_dwordx4 v13, s[44:47], s57 offen lds
    s_add_u32 m0, s56, 10240
    s_nop 0
    buffer_load_dwordx4 v13, s[48:51], s57 offen lds
    v_add_u32 v10, 320, v1
    v_mul_u32_u24 v11, 43691, v10
    v_lshrrev_b32 v11, 19, v11
    v_mul_u32_u24 v12, 12, v11
    v_sub_u32 v12, v10, v12
    v_mul_u32_u24 v11, 3072, v11
    v_lshl_add_u32 v13, v12, 4, v11
    s_add_u32 m0, s56, 5120
    s_nop 0
    buffer_load_dwordx4 v13, s[44:47], s57 offen lds
    s_add_u32 m0, s56, 11264
    s_nop 0
    buffer_load_dwordx4 v13, s[48:51], s57 offen lds
    s_waitcnt vmcnt(0)
    v_lshlrev_b32 v5, 4, v1
    v_bfe_u32 v6, v1, 2, 2
    v_lshl_add_u32 v6, v3, 2, v6
    v_and_b32 v7, 3, v1
    v_mul_u32_u24 v16, 192, v6
    v_lshl_add_u32 v16, v7, 3, v16
    v_add_u32 v16, s56, v16
    ds_read_b64_tr_b16 v[84:85], v16 offset:0
    ds_read_b64_tr_b16 v[86:87], v16 offset:3072
    ds_read_b64_tr_b16 v[88:89], v16 offset:32
    ds_read_b64_tr_b16 v[90:91], v16 offset:3104
    ds_read_b64_tr_b16 v[92:93], v16 offset:64
    ds_read_b64_tr_b16 v[94:95], v16 offset:3136
    ds_read_b64_tr_b16 v[96:97], v16 offset:6144
    ds_read_b64_tr_b16 v[98:99], v16 offset:9216
    ds_read_b64_tr_b16 v[100:101], v16 offset:6176
    ds_read_b64_tr_b16 v[102:103], v16 offset:9248
    ds_read_b64_tr_b16 v[104:105], v16 offset:6208
    ds_read_b64_tr_b16 v[106:107], v16 offset:9280
    ds_read_b64_tr_b16 v[108:109], v16 offset:128
    ds_read_b64_tr_b16 v[110:111], v16 offset:3200
    ds_read_b64_tr_b16 v[112:113], v16 offset:160
    ds_read_b64_tr_b16 v[114:115], v16 offset:3232
    ds_read_b64_tr_b16 v[116:117], v16 offset:96
    ds_read_b64_tr_b16 v[118:119], v16 offset:3168
    ds_read_b64_tr_b16 v[120:121], v16 offset:6272
    ds_read_b64_tr_b16 v[122:123], v16 offset:9344
    ds_read_b64_tr_b16 v[124:125], v16 offset:6304
    ds_read_b64_tr_b16 v[126:127], v16 offset:9376
    ds_read_b64_tr_b16 v[128:129], v16 offset:6240
    ds_read_b64_tr_b16 v[130:131], v16 offset:9312
    s_add_u32 s40, s4, 0x1000000
    s_addc_u32 s41, s5, 0
    s_mov_b32 s42, 3932160
    s_mov_b32 s43, 0x20000
    s_add_u32 s44, s4, 0x1600000
    s_addc_u32 s45, s5, 0
    s_mov_b32 s46, 246784
    s_mov_b32 s47, 0x20000
    s_mul_i32 s57, s55, 12288
    s_add_u32 s58, s57, 4096
    s_add_u32 s59, s57, 8192
    s_waitcnt lgkmcnt(0)
    buffer_store_dwordx4 v[84:87], v5, s[40:43], s57 offen offset:0 sc1
    buffer_store_dwordx4 v[88:91], v5, s[40:43], s57 offen offset:1024 sc1
    buffer_store_dwordx4 v[92:95], v5, s[40:43], s57 offen offset:2048 sc1
    buffer_store_dwordx4 v[96:99], v5, s[40:43], s57 offen offset:3072 sc1
    buffer_store_dwordx4 v[100:103], v5, s[40:43], s58 offen offset:0 sc1
    buffer_store_dwordx4 v[104:107], v5, s[40:43], s58 offen offset:1024 sc1
    buffer_store_dwordx4 v[108:111], v5, s[40:43], s58 offen offset:2048 sc1
    buffer_store_dwordx4 v[112:115], v5, s[40:43], s58 offen offset:3072 sc1
    buffer_store_dwordx4 v[116:119], v5, s[40:43], s59 offen offset:0 sc1
    buffer_store_dwordx4 v[120:123], v5, s[40:43], s59 offen offset:1024 sc1
    buffer_store_dwordx4 v[124:127], v5, s[40:43], s59 offen offset:2048 sc1
    buffer_store_dwordx4 v[128:131], v5, s[40:43], s59 offen offset:3072 sc1
    v_mov_b32 v8, 0x3f803f80
    v_lshlrev_b32 v9, 6, v4
    v_lshl_add_u32 v9, v3, 4, v9
    s_mul_i32 s60, s55, 768
    v_cmp_eq_u32 vcc, 0, v4
    s_nop 1
    v_cndmask_b32 v32, 0, v8, vcc
    v_cndmask_b32 v33, 0, v8, vcc
    v_cndmask_b32 v34, 0, v8, vcc
    v_cndmask_b32 v35, 0, v8, vcc
    v_cmp_eq_u32 vcc, 1, v4
    s_nop 1
    v_cndmask_b32 v36, 0, v8, vcc
    v_cndmask_b32 v37, 0, v8, vcc
    v_cndmask_b32 v38, 0, v8, vcc
    v_cndmask_b32 v39, 0, v8, vcc
    v_cmp_eq_u32 vcc, 2, v4
    s_nop 1
    v_cndmask_b32 v40, 0, v8, vcc
    v_cndmask_b32 v41, 0, v8, vcc
    v_cndmask_b32 v42, 0, v8, vcc
    v_cndmask_b32 v43, 0, v8, vcc
    v_cmp_eq_u32 vcc, 3, v4
    s_nop 1
    v_cndmask_b32 v44, 0, v8, vcc
    v_cndmask_b32 v45, 0, v8, vcc
    v_cndmask_b32 v46, 0, v8, vcc
    v_cndmask_b32 v47, 0, v8, vcc
    v_cmp_eq_u32 vcc, 4, v4
    s_nop 1
    v_cndmask_b32 v48, 0, v8, vcc
    v_cndmask_b32 v49, 0, v8, vcc
    v_cndmask_b32 v50, 0, v8, vcc
    v_cndmask_b32 v51, 0, v8, vcc
    v_cmp_eq_u32 vcc, 5, v4
    s_nop 1
    v_cndmask_b32 v52, 0, v8, vcc
    v_cndmask_b32 v53, 0, v8, vcc
    v_cndmask_b32 v54, 0, v8, vcc
    v_cndmask_b32 v55, 0, v8, vcc
    v_cmp_eq_u32 vcc, 6, v4
    s_nop 1
    v_cndmask_b32 v56, 0, v8, vcc
    v_cndmask_b32 v57, 0, v8, vcc
    v_cndmask_b32 v58, 0, v8, vcc
    v_cndmask_b32 v59, 0, v8, vcc
    v_cmp_eq_u32 vcc, 7, v4
    s_nop 1
    v_cndmask_b32 v60, 0, v8, vcc
    v_cndmask_b32 v61, 0, v8, vcc
    v_cndmask_b32 v62, 0, v8, vcc
    v_cndmask_b32 v63, 0, v8, vcc
    v_cmp_eq_u32 vcc, 8, v4
    s_nop 1
    v_cndmask_b32 v64, 0, v8, vcc
    v_cndmask_b32 v65, 0, v8, vcc
    v_cndmask_b32 v66, 0, v8, vcc
    v_cndmask_b32 v67, 0, v8, vcc
    v_cmp_eq_u32 vcc, 9, v4
    s_nop 1
    v_cndmask_b32 v68, 0, v8, vcc
    v_cndmask_b32 v69, 0, v8, vcc
    v_cndmask_b32 v70, 0, v8, vcc
    v_cndmask_b32 v71, 0, v8, vcc
    v_cmp_eq_u32 vcc, 10, v4
    s_nop 1
    v_cndmask_b32 v72, 0, v8, vcc
    v_cndmask_b32 v73, 0, v8, vcc
    v_cndmask_b32 v74, 0, v8, vcc
    v_cndmask_b32 v75, 0, v8, vcc
    v_cmp_eq_u32 vcc, 11, v4
    s_nop 1
    v_cndmask_b32 v76, 0, v8, vcc
    v_cndmask_b32 v77, 0, v8, vcc
    v_cndmask_b32 v78, 0, v8, vcc
    v_cndmask_b32 v79, 0, v8, vcc
    s_nop 1
    v_mfma_f32_16x16x32_bf16 v[80:83], v[84:87], v[32:35], 0
    v_mfma_f32_16x16x32_bf16 v[80:83], v[88:91], v[36:39], v[80:83]
    v_mfma_f32_16x16x32_bf16 v[80:83], v[92:95], v[40:43], v[80:83]
    v_mfma_f32_16x16x32_bf16 v[80:83], v[96:99], v[44:47], v[80:83]
    v_mfma_f32_16x16x32_bf16 v[80:83], v[100:103], v[48:51], v[80:83]
    v_mfma_f32_16x16x32_bf16 v[80:83], v[104:107], v[52:55], v[80:83]
    v_mfma_f32_16x16x32_bf16 v[80:83], v[108:111], v[56:59], v[80:83]
    v_mfma_f32_16x16x32_bf16 v[80:83], v[112:115], v[60:63], v[80:83]
    v_mfma_f32_16x16x32_bf16 v[80:83], v[116:119], v[64:67], v[80:83]
    v_mfma_f32_16x16x32_bf16 v[80:83], v[120:123], v[68:71], v[80:83]
    v_mfma_f32_16x16x32_bf16 v[80:83], v[124:127], v[72:75], v[80:83]
    v_mfma_f32_16x16x32_bf16 v[80:83], v[128:131], v[76:79], v[80:83]
    s_nop 7
    v_cmp_gt_u32 vcc, 12, v4
    s_and_saveexec_b64 s[82:83], vcc
    buffer_store_dwordx4 v[80:83], v9, s[44:47], s60 offen sc1
    s_mov_b64 exec, s[82:83]
    s_waitcnt vmcnt(0)
    s_mul_i32 s85, s55, 128
    s_add_u32 s85, s85, 98304
    v_mov_b32 v10, s3
    v_mov_b32 v11, s85
    s_mov_b64 exec, 1
    buffer_store_dword v10, v11, s[92:95], 0 offen sc1
    s_mov_b64 exec, -1
L_lnrp_6:
    s_branch L_aux_go
L_aux_rp:
    s_sub_u32 s52, s2, 224
    s_cmp_lt_u32 s6, 6
    s_cbranch_scc1 L_aux_rp1
    s_getpc_b64 s[54:55]
L_pc:
    s_sub_u32 s54, s54, L_pc-sequential_preLN__ssm_conv_s4d__glu_gated_swiglu__prompt_kernel
    s_subb_u32 s55, s55, 0
    v_lshlrev_b32 v5, 4, v1
    s_and_b32 s56, s6, 1
    s_mul_i32 s56, s56, 16384
    v_add_u32 v5, s56, v5
    global_load_dwordx4 v[16:19], v5, s[54:55] offset:0
    global_load_dwordx4 v[20:23], v5, s[54:55] offset:1024
    global_load_dwordx4 v[24:27], v5, s[54:55] offset:2048
    global_load_dwordx4 v[28:31], v5, s[54:55] offset:3072
    v_add_u32 v5, 4096, v5
    global_load_dwordx4 v[32:35], v5, s[54:55] offset:0
    global_load_dwordx4 v[36:39], v5, s[54:55] offset:1024
    global_load_dwordx4 v[40:43], v5, s[54:55] offset:2048
    global_load_dwordx4 v[44:47], v5, s[54:55] offset:3072
    v_add_u32 v5, 4096, v5
    global_load_dwordx4 v[48:51], v5, s[54:55] offset:0
    global_load_dwordx4 v[52:55], v5, s[54:55] offset:1024
    global_load_dwordx4 v[56:59], v5, s[54:55] offset:2048
    global_load_dwordx4 v[60:63], v5, s[54:55] offset:3072
    v_add_u32 v5, 4096, v5
    global_load_dwordx4 v[64:67], v5, s[54:55] offset:0
    global_load_dwordx4 v[68:71], v5, s[54:55] offset:1024
    global_load_dwordx4 v[72:75], v5, s[54:55] offset:2048
    global_load_dwordx4 v[76:79], v5, s[54:55] offset:3072
    v_add_u32 v5, 4096, v5
L_aux_rp1:
    s_waitcnt lgkmcnt(0)
    s_add_u32 s3, s3, 1
    s_cmp_ge_u32 s6, 6
    s_cbranch_scc1 L_aux_end
    s_mul_i32 s53, s52, 6
    s_add_u32 s53, s53, s6
    s_mul_i32 s54, s6, 12288
    v_lshlrev_b32 v5, 4, v1
    v_bfe_u32 v6, v1, 2, 2
    v_lshl_add_u32 v6, v3, 2, v6
    v_and_b32 v7, 3, v1
    s_mul_i32 s55, s53, 171
    s_lshr_b32 s55, s55, 12
    s_mul_i32 s56, s55, 24
    s_sub_u32 s56, s53, s56
    s_mov_b32 s32, s28
    s_mov_b32 s33, s29
    s_mov_b32 s34, 1966080
    s_mov_b32 s35, 0x20000
    s_mul_i32 s57, s55, 160
    s_mul_i32 s58, s56, 81920
    s_add_u32 s57, s57, s58
    s_add_u32 s58, s57, 40960
    v_add_u32 v8, 0, v1
    v_mul_u32_u24 v9, 52429, v8
    v_lshrrev_b32 v9, 19, v9
    v_mul_u32_u24 v16, 10, v9
    v_sub_u32 v16, v8, v16
    v_mul_u32_u24 v9, 1280, v9
    v_lshl_add_u32 v10, v16, 4, v9
    s_add_u32 m0, s54, 0
    s_nop 0
    buffer_load_dwordx4 v10, s[32:35], s57 offen lds
    s_add_u32 m0, s54, 5120
    s_nop 0
    buffer_load_dwordx4 v10, s[32:35], s58 offen lds
    v_add_u32 v8, 64, v1
    v_mul_u32_u24 v9, 52429, v8
    v_lshrrev_b32 v9, 19, v9
    v_mul_u32_u24 v16, 10, v9
    v_sub_u32 v16, v8, v16
    v_mul_u32_u24 v9, 1280, v9
    v_lshl_add_u32 v11, v16, 4, v9
    s_add_u32 m0, s54, 1024
    s_nop 0
    buffer_load_dwordx4 v11, s[32:35], s57 offen lds
    s_add_u32 m0, s54, 6144
    s_nop 0
    buffer_load_dwordx4 v11, s[32:35], s58 offen lds
    v_add_u32 v8, 128, v1
    v_mul_u32_u24 v9, 52429, v8
    v_lshrrev_b32 v9, 19, v9
    v_mul_u32_u24 v16, 10, v9
    v_sub_u32 v16, v8, v16
    v_mul_u32_u24 v9, 1280, v9
    v_lshl_add_u32 v12, v16, 4, v9
    s_add_u32 m0, s54, 2048
    s_nop 0
    buffer_load_dwordx4 v12, s[32:35], s57 offen lds
    s_add_u32 m0, s54, 7168
    s_nop 0
    buffer_load_dwordx4 v12, s[32:35], s58 offen lds
    v_add_u32 v8, 192, v1
    v_mul_u32_u24 v9, 52429, v8
    v_lshrrev_b32 v9, 19, v9
    v_mul_u32_u24 v16, 10, v9
    v_sub_u32 v16, v8, v16
    v_mul_u32_u24 v9, 1280, v9
    v_lshl_add_u32 v13, v16, 4, v9
    s_add_u32 m0, s54, 3072
    s_nop 0
    buffer_load_dwordx4 v13, s[32:35], s57 offen lds
    s_add_u32 m0, s54, 8192
    s_nop 0
    buffer_load_dwordx4 v13, s[32:35], s58 offen lds
    v_add_u32 v8, 256, v1
    v_mul_u32_u24 v9, 52429, v8
    v_lshrrev_b32 v9, 19, v9
    v_mul_u32_u24 v16, 10, v9
    v_sub_u32 v16, v8, v16
    v_mul_u32_u24 v9, 1280, v9
    v_lshl_add_u32 v14, v16, 4, v9
    s_add_u32 m0, s54, 4096
    s_nop 0
    buffer_load_dwordx4 v14, s[32:35], s57 offen lds
    s_add_u32 m0, s54, 9216
    s_nop 0
    buffer_load_dwordx4 v14, s[32:35], s58 offen lds
    s_add_u32 s40, s4, 0x1400000
    s_addc_u32 s41, s5, 0
    s_mov_b32 s42, 1966080
    s_mov_b32 s43, 0x20000
    s_mul_i32 s60, s56, 171
    s_lshr_b32 s60, s60, 9
    s_mul_i32 s60, s60, 3
    s_sub_u32 s60, s56, s60
    s_cmp_eq_u32 s60, 2
    s_cselect_b32 s61, 640, 0
    s_mul_i32 s62, s61, 3
    s_sub_u32 s62, 2560, s62
    v_mul_u32_u24 v16, 160, v6
    v_mul_u32_u24 v8, s61, v3
    v_add3_u32 v16, v16, v8, s54
    v_lshl_add_u32 v18, v7, 4, v16
    v_lshl_add_u32 v19, v7, 3, v16
    v_add_u32 v20, s62, v18
    v_add_u32 v21, s62, v19
    s_cmp_eq_u32 s60, 0
    s_cselect_b32 s61, 640, 0
    s_mul_i32 s62, s61, 3
    s_sub_u32 s62, 2560, s62
    v_mul_u32_u24 v16, 160, v6
    v_mul_u32_u24 v8, s61, v3
    v_add3_u32 v16, v16, v8, s54
    v_lshl_add_u32 v22, v7, 4, v16
    v_lshl_add_u32 v23, v7, 3, v16
    v_add_u32 v24, s62, v22
    v_add_u32 v25, s62, v23
    s_mul_i32 s57, s53, 10240
    s_add_u32 s58, s57, 4096
    s_add_u32 s59, s57, 8192
    v_add_u32 v26, 0, v1
    v_min_u32 v26, 63, v26
    v_mul_u32_u24 v26, 128, v26
    s_mov_b32 s86, 4096
    s_mov_b32 s84, 0
L_poll_7:
    buffer_load_dword v27, v26, s[92:95], s86 offen sc1
    s_waitcnt vmcnt(0)
    v_xor_b32 v27, s3, v27
    v_cmp_ne_u32 vcc, 0, v27
    s_cbranch_vccz L_polld_8
    s_sleep 4
    s_add_u32 s84, s84, 1
    s_cmp_lt_u32 s84, 400000
    s_cbranch_scc1 L_poll_7
L_polld_8:
    ds_read_b64_tr_b16 v[32:33], v18 offset:0
    ds_read_b64_tr_b16 v[34:35], v20 offset:0
    ds_read_b64_tr_b16 v[36:37], v18 offset:8
    ds_read_b64_tr_b16 v[38:39], v20 offset:8
    ds_read_b64_tr_b16 v[40:41], v18 offset:64
    ds_read_b64_tr_b16 v[42:43], v20 offset:64
    ds_read_b64_tr_b16 v[44:45], v18 offset:72
    ds_read_b64_tr_b16 v[46:47], v20 offset:72
    ds_read_b64_tr_b16 v[48:49], v19 offset:128
    ds_read_b64_tr_b16 v[50:51], v21 offset:128
    ds_read_b64_tr_b16 v[52:53], v22 offset:5120
    ds_read_b64_tr_b16 v[54:55], v24 offset:5120
    ds_read_b64_tr_b16 v[56:57], v22 offset:5128
    ds_read_b64_tr_b16 v[58:59], v24 offset:5128
    ds_read_b64_tr_b16 v[60:61], v22 offset:5184
    ds_read_b64_tr_b16 v[62:63], v24 offset:5184
    ds_read_b64_tr_b16 v[64:65], v22 offset:5192
    ds_read_b64_tr_b16 v[66:67], v24 offset:5192
    ds_read_b64_tr_b16 v[68:69], v23 offset:5248
    ds_read_b64_tr_b16 v[70:71], v25 offset:5248
    s_waitcnt lgkmcnt(0)
    buffer_store_dwordx4 v[32:35], v5, s[40:43], s57 offen offset:0 sc1
    buffer_store_dwordx4 v[36:39], v5, s[40:43], s57 offen offset:1024 sc1
    buffer_store_dwordx4 v[40:43], v5, s[40:43], s57 offen offset:2048 sc1
    buffer_store_dwordx4 v[44:47], v5, s[40:43], s57 offen offset:3072 sc1
    buffer_store_dwordx4 v[48:51], v5, s[40:43], s58 offen offset:0 sc1
    buffer_store_dwordx4 v[52:55], v5, s[40:43], s58 offen offset:1024 sc1
    buffer_store_dwordx4 v[56:59], v5, s[40:43], s58 offen offset:2048 sc1
    buffer_store_dwordx4 v[60:63], v5, s[40:43], s58 offen offset:3072 sc1
    buffer_store_dwordx4 v[64:67], v5, s[40:43], s59 offen offset:0 sc1
    buffer_store_dwordx4 v[68:71], v5, s[40:43], s59 offen offset:1024 sc1
L_aux_end:
    s_waitcnt vmcnt(0)
    s_barrier
    s_cmp_lg_u32 s6, 4
    s_cbranch_scc1 L_aux_go
    s_mul_i32 s85, s52, 128
    s_add_u32 s85, s85, 20480
    v_mov_b32 v10, s3
    v_mov_b32 v11, s85
    s_mov_b64 exec, 1
    buffer_store_dword v10, v11, s[92:95], 0 offen sc1
    s_mov_b64 exec, -1
L_aux_go:
    s_cmp_ge_u32 s6, 4
    s_cbranch_scc1 L_loader
    s_branch L_mfma
L_loader:
    s_and_b32 s12, s2, 7
    s_lshr_b32 s13, s2, 3
    s_and_b32 s14, s13, 7
    s_lshr_b32 s15, s13, 3
    s_and_b32 s8, s12, 1
    s_lshl_b32 s8, s8, 3
    s_add_u32 s8, s8, s14
    s_lshr_b32 s9, s12, 1
    s_lshl_b32 s10, s9, 3
    s_lshl_b32 s9, s9, 2
    s_add_u32 s9, s9, s15
    s_add_u32 s10, s10, s14
    s_and_b32 s11, s12, 1
    s_lshl_b32 s11, s11, 2
    s_add_u32 s11, s11, s15
    v_bfe_u32 v5, v1, 2, 2
    v_lshl_add_u32 v6, v3, 2, v5
    v_lshlrev_b32 v6, 8, v6
    v_and_b32 v7, 3, v1
    v_lshl_add_u32 v6, v7, 3, v6
    v_and_b32 v7, 1, v3
    v_lshl_add_u32 v5, v7, 2, v5
    s_mul_i32 s22, s8, 163840
    s_add_u32 s23, s22, 163840
    s_mul_i32 s24, s9, 245760
    s_add_u32 s25, s24, 245760
    s_lshr_b32 s20, s9, 3
    s_mul_i32 s20, s20, 5
    s_lshl_b32 s16, s20, 14
    s_add_u32 s16, s16, s22
    s_mul_i32 s17, s20, 24576
    s_add_u32 s17, s17, s24
    s_lshl_b32 s18, s7, 12
    s_mul_i32 s19, s7, 6144
    v_lshrrev_b32 v12, 1, v4
    v_xor_b32 v12, v12, v3
    v_lshlrev_b32 v12, 5, v12
    v_and_b32 v7, 1, v4
    v_lshlrev_b32 v7, 4, v7
    v_lshl_add_u32 v7, v3, 8, v7
    v_add_u32 v7, s18, v7
    v_add_u32 v8, v7, v12
    v_xor_b32 v12, 128, v12
    v_add_u32 v9, v7, v12
    v_lshlrev_b32 v10, 4, v1
    v_add_u32 v10, s19, v10
    v_add_u32 v11, 4096, v10
    s_add_u32 s32, s4, 0x700000
    s_addc_u32 s33, s5, 0
    s_mov_b32 s34, 2621440
    s_mov_b32 s35, 0x20000
    s_add_u32 s36, s4, 0x1000000
    s_addc_u32 s37, s5, 0
    s_mov_b32 s38, 3932160
    s_mov_b32 s39, 0x20000
    s_add_u32 s40, s4, 0x1600000
    s_addc_u32 s41, s5, 0
    s_mov_b32 s42, 246784
    s_mov_b32 s43, 0x20000
    s_mul_i32 s20, s9, 2560
    v_add_u32 v20, 0, v1
    v_min_u32 v20, 19, v20
    v_mul_u32_u24 v20, 128, v20
    s_add_u32 s86, s20, 98304
    s_mov_b32 s84, 0
L_poll_9:
    buffer_load_dword v21, v20, s[92:95], s86 offen sc1
    s_waitcnt vmcnt(0)
    v_xor_b32 v21, s3, v21
    v_cmp_ne_u32 vcc, 0, v21
    s_cbranch_vccz L_polld_10
    s_sleep 4
    s_add_u32 s84, s84, 1
    s_cmp_lt_u32 s84, 400000
    s_cbranch_scc1 L_poll_9
L_polld_10:
    v_and_b32 v13, 255, v0
    v_lshlrev_b32 v13, 2, v13
    s_mul_i32 s20, s9, 15360
    buffer_load_dword v40, v13, s[40:43], s20 offen offset:0 sc1
    buffer_load_dword v41, v13, s[40:43], s20 offen offset:768 sc1
    buffer_load_dword v42, v13, s[40:43], s20 offen offset:1536 sc1
    buffer_load_dword v43, v13, s[40:43], s20 offen offset:2304 sc1
    buffer_load_dword v44, v13, s[40:43], s20 offen offset:3072 sc1
    s_add_u32 s20, s20, 3840
    buffer_load_dword v45, v13, s[40:43], s20 offen offset:0 sc1
    buffer_load_dword v46, v13, s[40:43], s20 offen offset:768 sc1
    buffer_load_dword v47, v13, s[40:43], s20 offen offset:1536 sc1
    buffer_load_dword v48, v13, s[40:43], s20 offen offset:2304 sc1
    buffer_load_dword v49, v13, s[40:43], s20 offen offset:3072 sc1
    s_add_u32 s20, s20, 3840
    buffer_load_dword v50, v13, s[40:43], s20 offen offset:0 sc1
    buffer_load_dword v51, v13, s[40:43], s20 offen offset:768 sc1
    buffer_load_dword v52, v13, s[40:43], s20 offen offset:1536 sc1
    buffer_load_dword v53, v13, s[40:43], s20 offen offset:2304 sc1
    buffer_load_dword v54, v13, s[40:43], s20 offen offset:3072 sc1
    s_add_u32 s20, s20, 3840
    buffer_load_dword v55, v13, s[40:43], s20 offen offset:0 sc1
    buffer_load_dword v56, v13, s[40:43], s20 offen offset:768 sc1
    buffer_load_dword v57, v13, s[40:43], s20 offen offset:1536 sc1
    buffer_load_dword v58, v13, s[40:43], s20 offen offset:2304 sc1
    buffer_load_dword v59, v13, s[40:43], s20 offen offset:3072 sc1
    s_and_b32 s20, s9, 7
    v_xor_b32 v5, s20, v5
    v_lshl_add_u32 v14, v5, 5, v6
    v_add_u32 v15, 49152, v14
    v_mov_b32 v20, 0x3f803f80
    v_mov_b32 v21, 0x3f803f80
    v_mov_b32 v22, 0x3f803f80
    v_mov_b32 v23, 0x3f803f80
    v_mov_b32 v24, 0
    v_mov_b32 v25, 0
    v_mov_b32 v26, 0
    v_mov_b32 v27, 0
    v_mov_b32 v28, 0
    v_mov_b32 v29, 0
    v_mov_b32 v30, 0
    v_mov_b32 v31, 0
    s_waitcnt vmcnt(0)
    v_add_f32 v40, v40, v41
    v_add_f32 v40, v40, v42
    v_add_f32 v40, v40, v43
    v_add_f32 v40, v40, v44
    v_add_f32 v40, v40, v45
    v_add_f32 v40, v40, v46
    v_add_f32 v40, v40, v47
    v_add_f32 v40, v40, v48
    v_add_f32 v40, v40, v49
    v_add_f32 v40, v40, v50
    v_add_f32 v40, v40, v51
    v_add_f32 v40, v40, v52
    v_add_f32 v40, v40, v53
    v_add_f32 v40, v40, v54
    v_add_f32 v40, v40, v55
    v_add_f32 v40, v40, v56
    v_add_f32 v40, v40, v57
    v_add_f32 v40, v40, v58
    v_add_f32 v40, v40, v59
    v_and_b32 v7, 3, v4
    v_cmp_eq_u32 s[52:53], 1, v7
    v_cmp_eq_u32 s[54:55], 2, v7
    v_cmp_eq_u32 s[56:57], 3, v7
    v_lshrrev_b32 v7, 2, v4
    v_cmp_eq_u32 s[58:59], v7, v3
    s_mul_i32 s60, s11, 245760
    s_mul_i32 s62, s10, 196608
    s_mul_i32 s28, s7, 5120
    s_add_u32 s61, s60, 245760
    s_add_u32 s63, s62, 196608
    s_mul_i32 s26, s15, 0
    s_add_u32 s26, s26, s60
    s_mul_i32 s27, s15, 0
    s_add_u32 s27, s27, s62
    v_lshlrev_b32 v60, 4, v1
    v_add_u32 v61, s18, v60
    v_add_u32 v60, s28, v60
    v_add_u32 v62, 4096, v60
    s_add_u32 s40, s4, 0x1400000
    s_addc_u32 s41, s5, 0
    s_mov_b32 s42, 1966080
    s_mov_b32 s43, 0x20000
    s_add_u32 s44, s4, 0xa00000
    s_addc_u32 s45, s5, 0
    s_mov_b32 s46, 6291456
    s_mov_b32 s47, 0x20000
    s_barrier
    s_add_u32 m0, s19, 87040
    s_nop 0
    buffer_load_dwordx4 v10, s[36:39], s17 offen offset:0 sc1 lds
    buffer_load_dwordx4 v10, s[36:39], s17 offen offset:1024 sc1 lds
    buffer_load_dwordx4 v10, s[36:39], s17 offen offset:2048 sc1 lds
    buffer_load_dwordx4 v10, s[36:39], s17 offen offset:3072 sc1 lds
    s_add_u32 m0, s19, 91136
    s_nop 0
    buffer_load_dwordx4 v11, s[36:39], s17 offen offset:0 sc1 lds
    buffer_load_dwordx4 v11, s[36:39], s17 offen offset:1024 sc1 lds
    s_add_u32 s17, s17, 24576
    s_cmp_eq_u32 s17, s25
    s_cselect_b32 s17, s24, s17
    s_add_u32 m0, s19, 111616
    s_nop 0
    buffer_load_dwordx4 v10, s[36:39], s17 offen offset:0 sc1 lds
    buffer_load_dwordx4 v10, s[36:39], s17 offen offset:1024 sc1 lds
    buffer_load_dwordx4 v10, s[36:39], s17 offen offset:2048 sc1 lds
    buffer_load_dwordx4 v10, s[36:39], s17 offen offset:3072 sc1 lds
    s_add_u32 m0, s19, 115712
    s_nop 0
    buffer_load_dwordx4 v11, s[36:39], s17 offen offset:0 sc1 lds
    buffer_load_dwordx4 v11, s[36:39], s17 offen offset:1024 sc1 lds
    s_add_u32 s17, s17, 24576
    s_cmp_eq_u32 s17, s25
    s_cselect_b32 s17, s24, s17
    s_add_u32 m0, s19, 136192
    s_nop 0
    buffer_load_dwordx4 v10, s[36:39], s17 offen offset:0 sc1 lds
    buffer_load_dwordx4 v10, s[36:39], s17 offen offset:1024 sc1 lds
    buffer_load_dwordx4 v10, s[36:39], s17 offen offset:2048 sc1 lds
    buffer_load_dwordx4 v10, s[36:39], s17 offen offset:3072 sc1 lds
    s_add_u32 m0, s19, 140288
    s_nop 0
    buffer_load_dwordx4 v11, s[36:39], s17 offen offset:0 sc1 lds
    buffer_load_dwordx4 v11, s[36:39], s17 offen offset:1024 sc1 lds
    s_add_u32 s17, s17, 24576
    s_cmp_eq_u32 s17, s25
    s_cselect_b32 s17, s24, s17
    s_barrier
    ds_write_b32 v13, v40 offset:2048
    v_mov_b32 v16, 0
    ds_write_b32 v16, v16 offset:4096
    s_add_u32 m0, s18, 5120
    s_nop 0
    buffer_load_dwordx4 v8, s[32:35], s16 offen offset:0 sc1 lds
    buffer_load_dwordx4 v9, s[32:35], s16 offen offset:1024 sc1 lds
    buffer_load_dwordx4 v8, s[32:35], s16 offen offset:2048 sc1 lds
    buffer_load_dwordx4 v9, s[32:35], s16 offen offset:3072 sc1 lds
    s_add_u32 s16, s16, 16384
    s_cmp_eq_u32 s16, s23
    s_cselect_b32 s16, s22, s16
    s_add_u32 m0, s18, 21504
    s_nop 0
    buffer_load_dwordx4 v8, s[32:35], s16 offen offset:0 sc1 lds
    buffer_load_dwordx4 v9, s[32:35], s16 offen offset:1024 sc1 lds
    buffer_load_dwordx4 v8, s[32:35], s16 offen offset:2048 sc1 lds
    buffer_load_dwordx4 v9, s[32:35], s16 offen offset:3072 sc1 lds
    s_add_u32 s16, s16, 16384
    s_cmp_eq_u32 s16, s23
    s_cselect_b32 s16, s22, s16
    s_waitcnt vmcnt(4)
    s_barrier
    s_add_u32 m0, s18, 37888
    s_nop 0
    buffer_load_dwordx4 v8, s[32:35], s16 offen offset:0 sc1 lds
    buffer_load_dwordx4 v9, s[32:35], s16 offen offset:1024 sc1 lds
    buffer_load_dwordx4 v8, s[32:35], s16 offen offset:2048 sc1 lds
    buffer_load_dwordx4 v9, s[32:35], s16 offen offset:3072 sc1 lds
    s_add_u32 s16, s16, 16384
    s_cmp_eq_u32 s16, s23
    s_cselect_b32 s16, s22, s16
    s_add_u32 m0, s18, 54272
    s_nop 0
    buffer_load_dwordx4 v8, s[32:35], s16 offen offset:0 sc1 lds
    buffer_load_dwordx4 v9, s[32:35], s16 offen offset:1024 sc1 lds
    buffer_load_dwordx4 v8, s[32:35], s16 offen offset:2048 sc1 lds
    buffer_load_dwordx4 v9, s[32:35], s16 offen offset:3072 sc1 lds
    s_add_u32 s16, s16, 16384
    s_cmp_eq_u32 s16, s23
    s_cselect_b32 s16, s22, s16
    s_add_u32 m0, s18, 70656
    s_nop 0
    buffer_load_dwordx4 v8, s[32:35], s16 offen offset:0 sc1 lds
    buffer_load_dwordx4 v9, s[32:35], s16 offen offset:1024 sc1 lds
    buffer_load_dwordx4 v8, s[32:35], s16 offen offset:2048 sc1 lds
    buffer_load_dwordx4 v9, s[32:35], s16 offen offset:3072 sc1 lds
    s_add_u32 s16, s16, 16384
    s_cmp_eq_u32 s16, s23
    s_cselect_b32 s16, s22, s16
    s_add_u32 s48, s4, 0x1710000
    s_addc_u32 s49, s5, 0
    s_mov_b32 s50, 65536
    s_mov_b32 s51, 0x20000
    s_and_b32 s20, s7, 1
    s_lshl_b32 s20, s20, 13
    v_add_u32 v14, s20, v14
    v_add_u32 v15, s20, v15
    s_lshr_b32 s20, s7, 1
    s_cmp_lg_u32 s20, 0
    s_cbranch_scc1 L_nost_11
    ds_read_b64_tr_b16 v[32:33], v14 offset:5120
    ds_read_b64_tr_b16 v[34:35], v14 offset:9216
    s_waitcnt lgkmcnt(0)
    v_mfma_f32_16x16x32_bf16 v[24:27], v[20:23], v[32:35], v[24:27]
    v_mfma_f32_16x16x32_bf16 v[28:31], v[32:35], v[32:35], v[28:31]
L_nost_11:
    s_waitcnt vmcnt(12)
    s_barrier
    s_lshr_b32 s20, s7, 1
    s_cmp_lg_u32 s20, 1
    s_cbranch_scc1 L_nost_12
    ds_read_b64_tr_b16 v[32:33], v14 offset:21504
    ds_read_b64_tr_b16 v[34:35], v14 offset:25600
    s_waitcnt lgkmcnt(0)
    v_mfma_f32_16x16x32_bf16 v[24:27], v[20:23], v[32:35], v[24:27]
    v_mfma_f32_16x16x32_bf16 v[28:31], v[32:35], v[32:35], v[28:31]
L_nost_12:
    s_add_u32 m0, s19, 87040
    s_nop 0
    buffer_load_dwordx4 v10, s[36:39], s17 offen offset:0 sc1 lds
    buffer_load_dwordx4 v10, s[36:39], s17 offen offset:1024 sc1 lds
    buffer_load_dwordx4 v10, s[36:39], s17 offen offset:2048 sc1 lds
    buffer_load_dwordx4 v10, s[36:39], s17 offen offset:3072 sc1 lds
    s_add_u32 m0, s19, 91136
    s_nop 0
    buffer_load_dwordx4 v11, s[36:39], s17 offen offset:0 sc1 lds
    buffer_load_dwordx4 v11, s[36:39], s17 offen offset:1024 sc1 lds
    s_add_u32 s17, s17, 24576
    s_cmp_eq_u32 s17, s25
    s_cselect_b32 s17, s24, s17
    s_add_u32 m0, s18, 5120
    s_nop 0
    buffer_load_dwordx4 v8, s[32:35], s16 offen offset:0 sc1 lds
    buffer_load_dwordx4 v9, s[32:35], s16 offen offset:1024 sc1 lds
    buffer_load_dwordx4 v8, s[32:35], s16 offen offset:2048 sc1 lds
    buffer_load_dwordx4 v9, s[32:35], s16 offen offset:3072 sc1 lds
    s_add_u32 s16, s16, 16384
    s_cmp_eq_u32 s16, s23
    s_cselect_b32 s16, s22, s16
    s_waitcnt vmcnt(18)
    s_barrier
    s_lshr_b32 s20, s7, 1
    s_cmp_lg_u32 s20, 0
    s_cbranch_scc1 L_nost_13
    ds_read_b64_tr_b16 v[32:33], v14 offset:37888
    ds_read_b64_tr_b16 v[34:35], v14 offset:41984
    s_waitcnt lgkmcnt(0)
    v_mfma_f32_16x16x32_bf16 v[24:27], v[20:23], v[32:35], v[24:27]
    v_mfma_f32_16x16x32_bf16 v[28:31], v[32:35], v[32:35], v[28:31]
L_nost_13:
    s_add_u32 m0, s19, 111616
    s_nop 0
    buffer_load_dwordx4 v10, s[36:39], s17 offen offset:0 sc1 lds
    buffer_load_dwordx4 v10, s[36:39], s17 offen offset:1024 sc1 lds
    buffer_load_dwordx4 v10, s[36:39], s17 offen offset:2048 sc1 lds
    buffer_load_dwordx4 v10, s[36:39], s17 offen offset:3072 sc1 lds
    s_add_u32 m0, s19, 115712
    s_nop 0
    buffer_load_dwordx4 v11, s[36:39], s17 offen offset:0 sc1 lds
    buffer_load_dwordx4 v11, s[36:39], s17 offen offset:1024 sc1 lds
    s_add_u32 s17, s17, 24576
    s_cmp_eq_u32 s17, s25
    s_cselect_b32 s17, s24, s17
    s_add_u32 m0, s18, 21504
    s_nop 0
    buffer_load_dwordx4 v8, s[32:35], s16 offen offset:0 sc1 lds
    buffer_load_dwordx4 v9, s[32:35], s16 offen offset:1024 sc1 lds
    buffer_load_dwordx4 v8, s[32:35], s16 offen offset:2048 sc1 lds
    buffer_load_dwordx4 v9, s[32:35], s16 offen offset:3072 sc1 lds
    s_add_u32 s16, s16, 16384
    s_cmp_eq_u32 s16, s23
    s_cselect_b32 s16, s22, s16
    s_waitcnt vmcnt(24)
    s_waitcnt vmcnt(14)
    s_barrier
    s_lshr_b32 s20, s7, 1
    s_cmp_lg_u32 s20, 1
    s_cbranch_scc1 L_nost_14
    ds_read_b64_tr_b16 v[32:33], v15 offset:5120
    ds_read_b64_tr_b16 v[34:35], v15 offset:9216
    s_waitcnt lgkmcnt(0)
    v_mfma_f32_16x16x32_bf16 v[24:27], v[20:23], v[32:35], v[24:27]
    v_mfma_f32_16x16x32_bf16 v[28:31], v[32:35], v[32:35], v[28:31]
L_nost_14:
    s_add_u32 m0, s19, 136192
    s_nop 0
    buffer_load_dwordx4 v10, s[36:39], s17 offen offset:0 sc1 lds
    buffer_load_dwordx4 v10, s[36:39], s17 offen offset:1024 sc1 lds
    buffer_load_dwordx4 v10, s[36:39], s17 offen offset:2048 sc1 lds
    buffer_load_dwordx4 v10, s[36:39], s17 offen offset:3072 sc1 lds
    s_add_u32 m0, s19, 140288
    s_nop 0
    buffer_load_dwordx4 v11, s[36:39], s17 offen offset:0 sc1 lds
    buffer_load_dwordx4 v11, s[36:39], s17 offen offset:1024 sc1 lds
    s_add_u32 s17, s17, 24576
    s_cmp_eq_u32 s17, s25
    s_cselect_b32 s17, s24, s17
    s_add_u32 m0, s18, 37888
    s_nop 0
    buffer_load_dwordx4 v8, s[32:35], s16 offen offset:0 sc1 lds
    buffer_load_dwordx4 v9, s[32:35], s16 offen offset:1024 sc1 lds
    buffer_load_dwordx4 v8, s[32:35], s16 offen offset:2048 sc1 lds
    buffer_load_dwordx4 v9, s[32:35], s16 offen offset:3072 sc1 lds
    s_add_u32 s16, s16, 16384
    s_cmp_eq_u32 s16, s23
    s_cselect_b32 s16, s22, s16
    s_waitcnt vmcnt(30)
    s_waitcnt vmcnt(14)
    s_barrier
    s_lshr_b32 s20, s7, 1
    s_cmp_lg_u32 s20, 0
    s_cbranch_scc1 L_nost_15
    ds_read_b64_tr_b16 v[32:33], v15 offset:21504
    ds_read_b64_tr_b16 v[34:35], v15 offset:25600
    s_waitcnt lgkmcnt(0)
    v_mfma_f32_16x16x32_bf16 v[24:27], v[20:23], v[32:35], v[24:27]
    v_mfma_f32_16x16x32_bf16 v[28:31], v[32:35], v[32:35], v[28:31]
L_nost_15:
    s_add_u32 m0, s19, 87040
    s_nop 0
    buffer_load_dwordx4 v10, s[36:39], s17 offen offset:0 sc1 lds
    buffer_load_dwordx4 v10, s[36:39], s17 offen offset:1024 sc1 lds
    buffer_load_dwordx4 v10, s[36:39], s17 offen offset:2048 sc1 lds
    buffer_load_dwordx4 v10, s[36:39], s17 offen offset:3072 sc1 lds
    s_add_u32 m0, s19, 91136
    s_nop 0
    buffer_load_dwordx4 v11, s[36:39], s17 offen offset:0 sc1 lds
    buffer_load_dwordx4 v11, s[36:39], s17 offen offset:1024 sc1 lds
    s_add_u32 s17, s17, 24576
    s_cmp_eq_u32 s17, s25
    s_cselect_b32 s17, s24, s17
    s_add_u32 m0, s18, 54272
    s_nop 0
    buffer_load_dwordx4 v8, s[32:35], s16 offen offset:0 sc1 lds
    buffer_load_dwordx4 v9, s[32:35], s16 offen offset:1024 sc1 lds
    buffer_load_dwordx4 v8, s[32:35], s16 offen offset:2048 sc1 lds
    buffer_load_dwordx4 v9, s[32:35], s16 offen offset:3072 sc1 lds
    s_add_u32 s16, s16, 16384
    s_cmp_eq_u32 s16, s23
    s_cselect_b32 s16, s22, s16
    s_nop 4
    v_cndmask_b32 v28, v28, v29, s[52:53]
    v_cndmask_b32 v28, v28, v30, s[54:55]
    v_cndmask_b32 v25, v28, v31, s[56:57]
    s_lshl_b32 s20, s7, 7
    v_lshlrev_b32 v7, 3, v4
    v_add_u32 v7, s20, v7
    s_mov_b64 exec, s[58:59]
    ds_write_b64 v7, v[24:25] offset:3072
    s_mov_b64 exec, -1
    s_waitcnt lgkmcnt(0)
    s_waitcnt vmcnt(30)
    s_waitcnt vmcnt(14)
    s_barrier
    s_add_u32 m0, s19, 111616
    s_nop 0
    buffer_load_dwordx4 v10, s[36:39], s17 offen offset:0 sc1 lds
    buffer_load_dwordx4 v10, s[36:39], s17 offen offset:1024 sc1 lds
    buffer_load_dwordx4 v10, s[36:39], s17 offen offset:2048 sc1 lds
    buffer_load_dwordx4 v10, s[36:39], s17 offen offset:3072 sc1 lds
    s_add_u32 m0, s19, 115712
    s_nop 0
    buffer_load_dwordx4 v11, s[36:39], s17 offen offset:0 sc1 lds
    buffer_load_dwordx4 v11, s[36:39], s17 offen offset:1024 sc1 lds
    s_add_u32 s17, s17, 24576
    s_cmp_eq_u32 s17, s25
    s_cselect_b32 s17, s24, s17
    s_add_u32 m0, s18, 70656
    s_nop 0
    buffer_load_dwordx4 v8, s[32:35], s16 offen offset:0 sc1 lds
    buffer_load_dwordx4 v9, s[32:35], s16 offen offset:1024 sc1 lds
    buffer_load_dwordx4 v8, s[32:35], s16 offen offset:2048 sc1 lds
    buffer_load_dwordx4 v9, s[32:35], s16 offen offset:3072 sc1 lds
    s_add_u32 s16, s16, 16384
    s_cmp_eq_u32 s16, s23
    s_cselect_b32 s16, s22, s16
    s_cmp_lg_u32 s7, 3
    s_cbranch_scc1 L_nogr_16
    v_lshlrev_b32 v7, 3, v4
    ds_read_b64 v[32:33], v7 offset:3072
    ds_read_b64 v[34:35], v7 offset:3200
    ds_read_b64 v[36:37], v7 offset:3328
    ds_read_b64 v[38:39], v7 offset:3456
    s_lshl_b32 s20, s8, 1
    s_lshr_b32 s21, s9, 3
    s_add_u32 s20, s20, s21
    s_lshl_b32 s20, s20, 3
    s_and_b32 s21, s9, 7
    s_add_u32 s20, s20, s21
    s_lshl_b32 s20, s20, 8
    v_lshlrev_b32 v7, 4, v4
    v_mov_b32 v42, s3
    v_mov_b32 v43, s3
    s_waitcnt lgkmcnt(0)
    v_pk_add_f32 v[32:33], v[32:33], v[34:35]
    v_pk_add_f32 v[36:37], v[36:37], v[38:39]
    v_pk_add_f32 v[40:41], v[32:33], v[36:37]
    s_mov_b64 exec, 0xffff
    buffer_store_dwordx4 v[40:43], v7, s[48:51], s20 offen sc1
    s_mov_b64 exec, -1
L_nogr_16:
    s_waitcnt vmcnt(30)
    s_waitcnt vmcnt(14)
    s_barrier
    s_add_u32 m0, s19, 136192
    s_nop 0
    buffer_load_dwordx4 v10, s[36:39], s17 offen offset:0 sc1 lds
    buffer_load_dwordx4 v10, s[36:39], s17 offen offset:1024 sc1 lds
    buffer_load_dwordx4 v10, s[36:39], s17 offen offset:2048 sc1 lds
    buffer_load_dwordx4 v10, s[36:39], s17 offen offset:3072 sc1 lds
    s_add_u32 m0, s19, 140288
    s_nop 0
    buffer_load_dwordx4 v11, s[36:39], s17 offen offset:0 sc1 lds
    buffer_load_dwordx4 v11, s[36:39], s17 offen offset:1024 sc1 lds
    s_add_u32 s17, s17, 24576
    s_cmp_eq_u32 s17, s25
    s_cselect_b32 s17, s24, s17
    s_waitcnt vmcnt(26)
    s_waitcnt vmcnt(10)
    s_barrier
    s_add_u32 m0, s19, 87040
    s_nop 0
    buffer_load_dwordx4 v10, s[36:39], s17 offen offset:0 sc1 lds
    buffer_load_dwordx4 v10, s[36:39], s17 offen offset:1024 sc1 lds
    buffer_load_dwordx4 v10, s[36:39], s17 offen offset:2048 sc1 lds
    buffer_load_dwordx4 v10, s[36:39], s17 offen offset:3072 sc1 lds
    s_add_u32 m0, s19, 91136
    s_nop 0
    buffer_load_dwordx4 v11, s[36:39], s17 offen offset:0 sc1 lds
    buffer_load_dwordx4 v11, s[36:39], s17 offen offset:1024 sc1 lds
    s_add_u32 s17, s17, 24576
    s_cmp_eq_u32 s17, s25
    s_cselect_b32 s17, s24, s17
    s_add_u32 m0, s28, 5120
    s_nop 0
    buffer_load_dwordx4 v60, s[40:43], s26 offen offset:0 sc1 lds
    buffer_load_dwordx4 v60, s[40:43], s26 offen offset:1024 sc1 lds
    buffer_load_dwordx4 v60, s[40:43], s26 offen offset:2048 sc1 lds
    buffer_load_dwordx4 v60, s[40:43], s26 offen offset:3072 sc1 lds
    s_add_u32 m0, s28, 9216
    s_nop 0
    buffer_load_dwordx4 v62, s[40:43], s26 offen sc1 lds
    s_add_u32 s26, s26, 20480
    s_cmp_eq_u32 s26, s61
    s_cselect_b32 s26, s60, s26
    s_waitcnt vmcnt(27)
    s_waitcnt vmcnt(11)
    s_barrier
    s_lshl_b32 s20, s8, 12
    s_lshl_b32 s21, s7, 9
    s_add_u32 s20, s20, s21
    v_and_b32 v7, 31, v1
    v_lshlrev_b32 v7, 4, v7
    v_lshrrev_b32 v36, 5, v1
    v_lshl_add_u32 v36, v36, 11, v7
    v_add_u32 v7, s21, v7
    s_mov_b32 s84, 0
L_gp_17:
    buffer_load_dwordx4 v[40:43], v36, s[48:51], s20 offen sc1
    s_add_u32 s84, s84, 1
    s_waitcnt vmcnt(0)
    v_cmp_ne_u32 vcc, s3, v42
    s_cbranch_vccz L_gpd_18
    s_sleep 2
    s_cmp_lt_u32 s84, 400000
    s_cbranch_scc1 L_gp_17
L_gpd_18:
    v_mov_b32 v44, v40
    v_mov_b32 v45, v41
    s_nop 1
    v_permlane32_swap_b32 v40, v44
    v_permlane32_swap_b32 v41, v45
    v_add_f32 v40, v40, v44
    v_add_f32 v41, v41, v45
    v_mul_f32 v40, 0x3acccccd, v40
    v_mul_f32 v41, 0x3acccccd, v41
    v_fma_f32 v41, -v40, v40, v41
    v_max_f32 v41, 0, v41
    v_cvt_pk_bf16_f32 v44, v40, v40
    v_lshlrev_b32 v44, 16, v44
    v_xor_b32 v44, 0x80000000, v44
    v_cvt_pk_bf16_f32 v42, v41, v41
    v_lshlrev_b32 v42, 16, v42
    v_add_f32 v42, 0x3727c5ac, v42
    v_cvt_pk_bf16_f32 v42, v42, v42
    v_lshlrev_b32 v42, 16, v42
    v_sqrt_f32 v42, v42
    s_nop 0
    v_cvt_pk_bf16_f32 v42, v42, v42
    v_lshlrev_b32 v42, 16, v42
    v_rcp_f32 v45, v42
    s_nop 0
    v_mul_f32 v45, 0xbfb8aa3b, v45
    v_mul_f32 v46, v42, v42
    v_mov_b32 v47, 0
    ds_write_b128 v7, v[44:47] offset:0
    s_add_u32 m0, s28, 25600
    s_nop 0
    buffer_load_dwordx4 v60, s[40:43], s26 offen offset:0 sc1 lds
    buffer_load_dwordx4 v60, s[40:43], s26 offen offset:1024 sc1 lds
    buffer_load_dwordx4 v60, s[40:43], s26 offen offset:2048 sc1 lds
    buffer_load_dwordx4 v60, s[40:43], s26 offen offset:3072 sc1 lds
    s_add_u32 m0, s28, 29696
    s_nop 0
    buffer_load_dwordx4 v62, s[40:43], s26 offen sc1 lds
    s_add_u32 s26, s26, 20480
    s_cmp_eq_u32 s26, s61
    s_cselect_b32 s26, s60, s26
    s_waitcnt vmcnt(22)
    s_waitcnt vmcnt(10)
    s_barrier
    s_add_u32 m0, s28, 46080
    s_nop 0
    buffer_load_dwordx4 v60, s[40:43], s26 offen offset:0 sc1 lds
    buffer_load_dwordx4 v60, s[40:43], s26 offen offset:1024 sc1 lds
    buffer_load_dwordx4 v60, s[40:43], s26 offen offset:2048 sc1 lds
    buffer_load_dwordx4 v60, s[40:43], s26 offen offset:3072 sc1 lds
    s_add_u32 m0, s28, 50176
    s_nop 0
    buffer_load_dwordx4 v62, s[40:43], s26 offen sc1 lds
    s_add_u32 s26, s26, 20480
    s_cmp_eq_u32 s26, s61
    s_cselect_b32 s26, s60, s26
    s_add_u32 m0, s28, 128000
    s_nop 0
    buffer_load_dwordx4 v60, s[40:43], s26 offen offset:0 sc1 lds
    buffer_load_dwordx4 v60, s[40:43], s26 offen offset:1024 sc1 lds
    buffer_load_dwordx4 v60, s[40:43], s26 offen offset:2048 sc1 lds
    buffer_load_dwordx4 v60, s[40:43], s26 offen offset:3072 sc1 lds
    s_add_u32 m0, s28, 132096
    s_nop 0
    buffer_load_dwordx4 v62, s[40:43], s26 offen sc1 lds
    s_add_u32 s26, s26, 20480
    s_cmp_eq_u32 s26, s61
    s_cselect_b32 s26, s60, s26
    s_barrier
    s_add_u32 m0, s28, 66560
    s_nop 0
    buffer_load_dwordx4 v60, s[40:43], s26 offen offset:0 sc1 lds
    buffer_load_dwordx4 v60, s[40:43], s26 offen offset:1024 sc1 lds
    buffer_load_dwordx4 v60, s[40:43], s26 offen offset:2048 sc1 lds
    buffer_load_dwordx4 v60, s[40:43], s26 offen offset:3072 sc1 lds
    s_add_u32 m0, s28, 70656
    s_nop 0
    buffer_load_dwordx4 v62, s[40:43], s26 offen sc1 lds
    s_add_u32 s26, s26, 20480
    s_cmp_eq_u32 s26, s61
    s_cselect_b32 s26, s60, s26
    s_add_u32 m0, s28, 87040
    s_nop 0
    buffer_load_dwordx4 v60, s[40:43], s26 offen offset:0 sc1 lds
    buffer_load_dwordx4 v60, s[40:43], s26 offen offset:1024 sc1 lds
    buffer_load_dwordx4 v60, s[40:43], s26 offen offset:2048 sc1 lds
    buffer_load_dwordx4 v60, s[40:43], s26 offen offset:3072 sc1 lds
    s_add_u32 m0, s28, 91136
    s_nop 0
    buffer_load_dwordx4 v62, s[40:43], s26 offen sc1 lds
    s_add_u32 s26, s26, 20480
    s_cmp_eq_u32 s26, s61
    s_cselect_b32 s26, s60, s26
    s_add_u32 m0, s28, 107520
    s_nop 0
    buffer_load_dwordx4 v60, s[40:43], s26 offen offset:0 sc1 lds
    buffer_load_dwordx4 v60, s[40:43], s26 offen offset:1024 sc1 lds
    buffer_load_dwordx4 v60, s[40:43], s26 offen offset:2048 sc1 lds
    buffer_load_dwordx4 v60, s[40:43], s26 offen offset:3072 sc1 lds
    s_add_u32 m0, s28, 111616
    s_nop 0
    buffer_load_dwordx4 v62, s[40:43], s26 offen sc1 lds
    s_add_u32 s26, s26, 20480
    s_cmp_eq_u32 s26, s61
    s_cselect_b32 s26, s60, s26
    s_waitcnt lgkmcnt(0)
    s_barrier
    s_waitcnt vmcnt(0)
    s_barrier
    s_barrier
    s_add_u32 m0, s28, 5120
    s_nop 0
    buffer_load_dwordx4 v60, s[40:43], s26 offen offset:0 sc1 lds
    buffer_load_dwordx4 v60, s[40:43], s26 offen offset:1024 sc1 lds
    buffer_load_dwordx4 v60, s[40:43], s26 offen offset:2048 sc1 lds
    buffer_load_dwordx4 v60, s[40:43], s26 offen offset:3072 sc1 lds
    s_add_u32 m0, s28, 9216
    s_nop 0
    buffer_load_dwordx4 v62, s[40:43], s26 offen sc1 lds
    s_add_u32 s26, s26, 20480
    s_cmp_eq_u32 s26, s61
    s_cselect_b32 s26, s60, s26
    s_add_u32 m0, s28, 25600
    s_nop 0
    buffer_load_dwordx4 v60, s[40:43], s26 offen offset:0 sc1 lds
    buffer_load_dwordx4 v60, s[40:43], s26 offen offset:1024 sc1 lds
    buffer_load_dwordx4 v60, s[40:43], s26 offen offset:2048 sc1 lds
    buffer_load_dwordx4 v60, s[40:43], s26 offen offset:3072 sc1 lds
    s_add_u32 m0, s28, 29696
    s_nop 0
    buffer_load_dwordx4 v62, s[40:43], s26 offen sc1 lds
    s_add_u32 s26, s26, 20480
    s_cmp_eq_u32 s26, s61
    s_cselect_b32 s26, s60, s26
    s_add_u32 m0, s28, 46080
    s_nop 0
    buffer_load_dwordx4 v60, s[40:43], s26 offen offset:0 sc1 lds
    buffer_load_dwordx4 v60, s[40:43], s26 offen offset:1024 sc1 lds
    buffer_load_dwordx4 v60, s[40:43], s26 offen offset:2048 sc1 lds
    buffer_load_dwordx4 v60, s[40:43], s26 offen offset:3072 sc1 lds
    s_add_u32 m0, s28, 50176
    s_nop 0
    buffer_load_dwordx4 v62, s[40:43], s26 offen sc1 lds
    s_add_u32 s26, s26, 20480
    s_cmp_eq_u32 s26, s61
    s_cselect_b32 s26, s60, s26
    s_barrier
    s_add_u32 m0, s28, 128000
    s_nop 0
    buffer_load_dwordx4 v60, s[40:43], s26 offen offset:0 sc1 lds
    buffer_load_dwordx4 v60, s[40:43], s26 offen offset:1024 sc1 lds
    buffer_load_dwordx4 v60, s[40:43], s26 offen offset:2048 sc1 lds
    buffer_load_dwordx4 v60, s[40:43], s26 offen offset:3072 sc1 lds
    s_add_u32 m0, s28, 132096
    s_nop 0
    buffer_load_dwordx4 v62, s[40:43], s26 offen sc1 lds
    s_add_u32 s26, s26, 20480
    s_cmp_eq_u32 s26, s61
    s_cselect_b32 s26, s60, s26
    s_add_u32 m0, s28, 66560
    s_nop 0
    buffer_load_dwordx4 v60, s[40:43], s26 offen offset:0 sc1 lds
    buffer_load_dwordx4 v60, s[40:43], s26 offen offset:1024 sc1 lds
    buffer_load_dwordx4 v60, s[40:43], s26 offen offset:2048 sc1 lds
    buffer_load_dwordx4 v60, s[40:43], s26 offen offset:3072 sc1 lds
    s_add_u32 m0, s28, 70656
    s_nop 0
    buffer_load_dwordx4 v62, s[40:43], s26 offen sc1 lds
    s_add_u32 s26, s26, 20480
    s_cmp_eq_u32 s26, s61
    s_cselect_b32 s26, s60, s26
    s_waitcnt vmcnt(10)
    s_barrier
    s_waitcnt vmcnt(0)
    s_barrier
    s_barrier
    s_branch L_done
L_mfma:
    s_and_b32 s12, s2, 7
    s_lshr_b32 s13, s2, 3
    s_and_b32 s14, s13, 7
    s_lshr_b32 s15, s13, 3
    s_and_b32 s8, s12, 1
    s_lshl_b32 s8, s8, 3
    s_add_u32 s8, s8, s14
    s_lshr_b32 s9, s12, 1
    s_lshl_b32 s10, s9, 3
    s_lshl_b32 s9, s9, 2
    s_add_u32 s9, s9, s15
    s_add_u32 s10, s10, s14
    s_and_b32 s11, s12, 1
    s_lshl_b32 s11, s11, 2
    s_add_u32 s11, s11, s15
    v_bfe_u32 v5, v1, 2, 2
    v_lshl_add_u32 v6, v3, 2, v5
    v_lshlrev_b32 v6, 8, v6
    v_and_b32 v7, 3, v1
    v_lshl_add_u32 v6, v7, 3, v6
    v_and_b32 v7, 1, v3
    v_lshl_add_u32 v5, v7, 2, v5
    s_barrier
    s_and_b32 s16, s7, 1
    s_lshr_b32 s17, s7, 1
    s_lshl_b32 s18, s16, 2
    v_xor_b32 v5, s18, v5
    v_xor_b32 v7, 0, v5
    v_lshl_add_u32 v12, v7, 5, v6
    v_xor_b32 v7, 1, v5
    v_lshl_add_u32 v13, v7, 5, v6
    v_xor_b32 v7, 2, v5
    v_lshl_add_u32 v14, v7, 5, v6
    v_xor_b32 v7, 3, v5
    v_lshl_add_u32 v15, v7, 5, v6
    v_lshlrev_b32 v16, 4, v1
    s_mul_i32 s18, s17, 6144
    v_add_u32 v16, s18, v16
    v_mov_b32 v24, 0
    v_mov_b32 v25, 0
    v_mov_b32 v26, 0
    v_mov_b32 v27, 0
    v_mov_b32 v28, 0
    v_mov_b32 v29, 0
    v_mov_b32 v30, 0
    v_mov_b32 v31, 0
    v_mov_b32 v32, 0
    v_mov_b32 v33, 0
    v_mov_b32 v34, 0
    v_mov_b32 v35, 0
    v_mov_b32 v36, 0
    v_mov_b32 v37, 0
    v_mov_b32 v38, 0
    v_mov_b32 v39, 0
    v_mov_b32 v40, 0
    v_mov_b32 v41, 0
    v_mov_b32 v42, 0
    v_mov_b32 v43, 0
    v_mov_b32 v44, 0
    v_mov_b32 v45, 0
    v_mov_b32 v46, 0
    v_mov_b32 v47, 0
    v_mov_b32 v48, 0
    v_mov_b32 v49, 0
    v_mov_b32 v50, 0
    v_mov_b32 v51, 0
    v_mov_b32 v52, 0
    v_mov_b32 v53, 0
    v_mov_b32 v54, 0
    v_mov_b32 v55, 0
    v_mov_b32 v56, 0
    v_mov_b32 v57, 0
    v_mov_b32 v58, 0
    v_mov_b32 v59, 0
    v_mov_b32 v60, 0
    v_mov_b32 v61, 0
    v_mov_b32 v62, 0
    v_mov_b32 v63, 0
    v_mov_b32 v64, 0
    v_mov_b32 v65, 0
    v_mov_b32 v66, 0
    v_mov_b32 v67, 0
    v_mov_b32 v68, 0
    v_mov_b32 v69, 0
    v_mov_b32 v70, 0
    v_mov_b32 v71, 0
    v_mov_b32 v72, 0
    v_mov_b32 v73, 0
    v_mov_b32 v74, 0
    v_mov_b32 v75, 0
    v_mov_b32 v76, 0
    v_mov_b32 v77, 0
    v_mov_b32 v78, 0
    v_mov_b32 v79, 0
    v_mov_b32 v80, 0
    v_mov_b32 v81, 0
    v_mov_b32 v82, 0
    v_mov_b32 v83, 0
    v_mov_b32 v84, 0
    v_mov_b32 v85, 0
    v_mov_b32 v86, 0
    v_mov_b32 v87, 0
    v_mov_b32 v88, 0
    v_mov_b32 v89, 0
    v_mov_b32 v90, 0
    v_mov_b32 v91, 0
    v_mov_b32 v92, 0
    v_mov_b32 v93, 0
    v_mov_b32 v94, 0
    v_mov_b32 v95, 0
    v_mov_b32 v96, 0
    v_mov_b32 v97, 0
    v_mov_b32 v98, 0
    v_mov_b32 v99, 0
    v_mov_b32 v100, 0
    v_mov_b32 v101, 0
    v_mov_b32 v102, 0
    v_mov_b32 v103, 0
    v_mov_b32 v104, 0
    v_mov_b32 v105, 0
    v_mov_b32 v106, 0
    v_mov_b32 v107, 0
    v_mov_b32 v108, 0
    v_mov_b32 v109, 0
    v_mov_b32 v110, 0
    v_mov_b32 v111, 0
    v_mov_b32 v112, 0
    v_mov_b32 v113, 0
    v_mov_b32 v114, 0
    v_mov_b32 v115, 0
    v_mov_b32 v116, 0
    v_mov_b32 v117, 0
    v_mov_b32 v118, 0
    v_mov_b32 v119, 0
    v_add_u32 v17, 5120, v12
    v_add_u32 v18, 5120, v13
    v_add_u32 v19, 5120, v14
    v_add_u32 v20, 5120, v15
    v_add_u32 v21, 87040, v16
    s_mov_b32 s19, 5120
    s_mov_b32 s20, 87040
    s_mov_b32 s21, 0
    s_add_u32 s32, s4, 0xa00000
    s_addc_u32 s33, s5, 0
    s_mov_b32 s34, 6291456
    s_mov_b32 s35, 0x20000
    s_cmp_lg_u32 s6, 0
    s_cbranch_scc1 L_nopoll_19
    v_add_u32 v120, 0, v1
    v_min_u32 v120, 31, v120
    v_mul_u32_u24 v120, 128, v120
    s_mov_b32 s86, 20480
    s_mov_b32 s84, 0
L_poll_20:
    buffer_load_dword v121, v120, s[92:95], s86 offen sc1
    s_waitcnt vmcnt(0)
    v_xor_b32 v121, s3, v121
    v_cmp_ne_u32 vcc, 0, v121
    s_cbranch_vccz L_polld_21
    s_sleep 4
    s_add_u32 s84, s84, 1
    s_cmp_lt_u32 s84, 400000
    s_cbranch_scc1 L_poll_20
L_polld_21:
    v_add_u32 v120, 0, v1
    v_min_u32 v120, 159, v120
    v_mul_u32_u24 v120, 128, v120
    v_add_u32 v121, 64, v1
    v_min_u32 v121, 159, v121
    v_mul_u32_u24 v121, 128, v121
    v_add_u32 v122, 128, v1
    v_min_u32 v122, 159, v122
    v_mul_u32_u24 v122, 128, v122
    s_mov_b32 s86, 32768
    s_mov_b32 s84, 0
L_poll_22:
    buffer_load_dword v123, v120, s[92:95], s86 offen sc1
    buffer_load_dword v124, v121, s[92:95], s86 offen sc1
    buffer_load_dword v125, v122, s[92:95], s86 offen sc1
    s_waitcnt vmcnt(0)
    v_xor_b32 v123, s3, v123
    v_xor_b32 v124, s3, v124
    v_xor_b32 v125, s3, v125
    v_or_b32 v123, v123, v124
    v_or_b32 v123, v123, v125
    v_cmp_ne_u32 vcc, 0, v123
    s_cbranch_vccz L_polld_23
    s_sleep 3
    s_add_u32 s84, s84, 1
    s_cmp_lt_u32 s84, 400000
    s_cbranch_scc1 L_poll_22
L_polld_23:
    s_cmp_lg_u32 s2, 0
    s_cbranch_scc1 L_nopoll_19
    v_mov_b32 v120, s3
    v_mov_b32 v121, 0
    s_mov_b64 exec, 1
    buffer_store_dword v120, v121, s[92:95], 0 offen
    s_mov_b64 exec, -1
L_nopoll_19:
    s_barrier
    s_waitcnt vmcnt(0)
    s_barrier
    ds_read_b64_tr_b16 v[120:121], v17 offset:0
    ds_read_b64_tr_b16 v[122:123], v17 offset:4096
    ds_read_b64_tr_b16 v[124:125], v18 offset:0
    ds_read_b64_tr_b16 v[126:127], v18 offset:4096
    ds_read_b64_tr_b16 v[128:129], v19 offset:0
    ds_read_b64_tr_b16 v[130:131], v19 offset:4096
    ds_read_b64_tr_b16 v[132:133], v20 offset:0
    ds_read_b64_tr_b16 v[134:135], v20 offset:4096
    ds_read_b128 v[136:139], v21 offset:0
    ds_read_b128 v[140:143], v21 offset:1024
    ds_read_b128 v[144:147], v21 offset:2048
    ds_read_b128 v[148:151], v21 offset:3072
    ds_read_b128 v[152:155], v21 offset:4096
    ds_read_b128 v[156:159], v21 offset:5120
L_g1:
    s_add_u32 s19, s19, 16384
    s_cmp_eq_u32 s19, 87040
    s_cselect_b32 s19, 5120, s19
    s_add_u32 s20, s20, 24576
    s_cmp_eq_u32 s20, 160768
    s_cselect_b32 s20, 87040, s20
    s_waitcnt lgkmcnt(0)
    v_mfma_f32_16x16x32_bf16 v[24:27], v[136:139], v[120:123], v[24:27]
    ds_read_b64_tr_b16 v[160:161], v17 offset:8192
    v_mfma_f32_16x16x32_bf16 v[28:31], v[136:139], v[124:127], v[28:31]
    ds_read_b64_tr_b16 v[162:163], v17 offset:12288
    v_mfma_f32_16x16x32_bf16 v[32:35], v[136:139], v[128:131], v[32:35]
    ds_read_b64_tr_b16 v[164:165], v18 offset:8192
    v_mfma_f32_16x16x32_bf16 v[36:39], v[136:139], v[132:135], v[36:39]
    ds_read_b64_tr_b16 v[166:167], v18 offset:12288
    v_mfma_f32_16x16x32_bf16 v[40:43], v[140:143], v[120:123], v[40:43]
    ds_read_b64_tr_b16 v[168:169], v19 offset:8192
    v_mfma_f32_16x16x32_bf16 v[44:47], v[140:143], v[124:127], v[44:47]
    ds_read_b64_tr_b16 v[170:171], v19 offset:12288
    v_mfma_f32_16x16x32_bf16 v[48:51], v[140:143], v[128:131], v[48:51]
    ds_read_b64_tr_b16 v[172:173], v20 offset:8192
    v_mfma_f32_16x16x32_bf16 v[52:55], v[140:143], v[132:135], v[52:55]
    ds_read_b64_tr_b16 v[174:175], v20 offset:12288
    v_mfma_f32_16x16x32_bf16 v[56:59], v[144:147], v[120:123], v[56:59]
    ds_read_b128 v[176:179], v21 offset:12288
    v_mfma_f32_16x16x32_bf16 v[60:63], v[144:147], v[124:127], v[60:63]
    ds_read_b128 v[180:183], v21 offset:13312
    v_mfma_f32_16x16x32_bf16 v[64:67], v[144:147], v[128:131], v[64:67]
    ds_read_b128 v[184:187], v21 offset:14336
    v_mfma_f32_16x16x32_bf16 v[68:71], v[144:147], v[132:135], v[68:71]
    ds_read_b128 v[188:191], v21 offset:15360
    v_mfma_f32_16x16x32_bf16 v[72:75], v[148:151], v[120:123], v[72:75]
    ds_read_b128 v[192:195], v21 offset:16384
    v_mfma_f32_16x16x32_bf16 v[76:79], v[148:151], v[124:127], v[76:79]
    ds_read_b128 v[196:199], v21 offset:17408
    v_mfma_f32_16x16x32_bf16 v[80:83], v[148:151], v[128:131], v[80:83]
    v_add_u32 v17, s19, v12
    v_mfma_f32_16x16x32_bf16 v[84:87], v[148:151], v[132:135], v[84:87]
    v_add_u32 v18, s19, v13
    v_mfma_f32_16x16x32_bf16 v[88:91], v[152:155], v[120:123], v[88:91]
    v_add_u32 v19, s19, v14
    v_mfma_f32_16x16x32_bf16 v[92:95], v[152:155], v[124:127], v[92:95]
    v_add_u32 v20, s19, v15
    v_mfma_f32_16x16x32_bf16 v[96:99], v[152:155], v[128:131], v[96:99]
    v_add_u32 v21, s20, v16
    v_mfma_f32_16x16x32_bf16 v[100:103], v[152:155], v[132:135], v[100:103]
    v_mfma_f32_16x16x32_bf16 v[104:107], v[156:159], v[120:123], v[104:107]
    v_mfma_f32_16x16x32_bf16 v[108:111], v[156:159], v[124:127], v[108:111]
    v_mfma_f32_16x16x32_bf16 v[112:115], v[156:159], v[128:131], v[112:115]
    v_mfma_f32_16x16x32_bf16 v[116:119], v[156:159], v[132:135], v[116:119]
    s_waitcnt lgkmcnt(0)
    s_barrier
    v_mfma_f32_16x16x32_bf16 v[24:27], v[176:179], v[160:163], v[24:27]
    ds_read_b64_tr_b16 v[120:121], v17 offset:0
    v_mfma_f32_16x16x32_bf16 v[28:31], v[176:179], v[164:167], v[28:31]
    ds_read_b64_tr_b16 v[122:123], v17 offset:4096
    v_mfma_f32_16x16x32_bf16 v[32:35], v[176:179], v[168:171], v[32:35]
    ds_read_b64_tr_b16 v[124:125], v18 offset:0
    v_mfma_f32_16x16x32_bf16 v[36:39], v[176:179], v[172:175], v[36:39]
    ds_read_b64_tr_b16 v[126:127], v18 offset:4096
    v_mfma_f32_16x16x32_bf16 v[40:43], v[180:183], v[160:163], v[40:43]
    ds_read_b64_tr_b16 v[128:129], v19 offset:0
    v_mfma_f32_16x16x32_bf16 v[44:47], v[180:183], v[164:167], v[44:47]
    ds_read_b64_tr_b16 v[130:131], v19 offset:4096
    v_mfma_f32_16x16x32_bf16 v[48:51], v[180:183], v[168:171], v[48:51]
    ds_read_b64_tr_b16 v[132:133], v20 offset:0
    v_mfma_f32_16x16x32_bf16 v[52:55], v[180:183], v[172:175], v[52:55]
    ds_read_b64_tr_b16 v[134:135], v20 offset:4096
    v_mfma_f32_16x16x32_bf16 v[56:59], v[184:187], v[160:163], v[56:59]
    ds_read_b128 v[136:139], v21 offset:0
    v_mfma_f32_16x16x32_bf16 v[60:63], v[184:187], v[164:167], v[60:63]
    ds_read_b128 v[140:143], v21 offset:1024
    v_mfma_f32_16x16x32_bf16 v[64:67], v[184:187], v[168:171], v[64:67]
    ds_read_b128 v[144:147], v21 offset:2048
    v_mfma_f32_16x16x32_bf16 v[68:71], v[184:187], v[172:175], v[68:71]
    ds_read_b128 v[148:151], v21 offset:3072
    v_mfma_f32_16x16x32_bf16 v[72:75], v[188:191], v[160:163], v[72:75]
    ds_read_b128 v[152:155], v21 offset:4096
    v_mfma_f32_16x16x32_bf16 v[76:79], v[188:191], v[164:167], v[76:79]
    ds_read_b128 v[156:159], v21 offset:5120
    v_mfma_f32_16x16x32_bf16 v[80:83], v[188:191], v[168:171], v[80:83]
    v_mfma_f32_16x16x32_bf16 v[84:87], v[188:191], v[172:175], v[84:87]
    v_mfma_f32_16x16x32_bf16 v[88:91], v[192:195], v[160:163], v[88:91]
    v_mfma_f32_16x16x32_bf16 v[92:95], v[192:195], v[164:167], v[92:95]
    v_mfma_f32_16x16x32_bf16 v[96:99], v[192:195], v[168:171], v[96:99]
    v_mfma_f32_16x16x32_bf16 v[100:103], v[192:195], v[172:175], v[100:103]
    v_mfma_f32_16x16x32_bf16 v[104:107], v[196:199], v[160:163], v[104:107]
    v_mfma_f32_16x16x32_bf16 v[108:111], v[196:199], v[164:167], v[108:111]
    v_mfma_f32_16x16x32_bf16 v[112:115], v[196:199], v[168:171], v[112:115]
    v_mfma_f32_16x16x32_bf16 v[116:119], v[196:199], v[172:175], v[116:119]
    s_add_u32 s21, s21, 1
    s_cmp_lt_u32 s21, 10
    s_cbranch_scc1 L_g1
    s_lshl_b32 s18, s16, 10
    v_lshlrev_b32 v5, 4, v4
    v_add_u32 v5, s18, v5
    s_mul_i32 s18, s17, 384
    v_lshlrev_b32 v6, 4, v3
    v_add_u32 v6, s18, v6
    s_lshl_b32 s22, s8, 1
    s_add_u32 s22, s22, s16
    s_mul_i32 s22, s22, 48
    s_mul_i32 s23, s9, 3
    s_add_u32 s22, s22, s23
    s_lshl_b32 s23, s17, 1
    s_add_u32 s23, s23, s22
    s_lshl_b32 s23, s23, 12
    s_add_u32 s22, s22, 1
    s_lshl_b32 s22, s22, 12
    s_lshl_b32 s18, s17, 9
    s_add_u32 s22, s22, s18
    v_and_b32 v7, 1, v3
    v_lshlrev_b32 v7, 10, v7
    v_lshrrev_b32 v8, 1, v3
    v_lshl_add_u32 v7, v8, 8, v7
    v_lshl_add_u32 v7, v4, 4, v7
    s_waitcnt lgkmcnt(0)
    s_barrier
    ds_read_b128 v[184:187], v5 offset:0
    ds_read_b128 v[188:191], v5 offset:256
    ds_read_b128 v[192:195], v5 offset:512
    ds_read_b128 v[196:199], v5 offset:768
    ds_read_b128 v[160:163], v6 offset:2048
    ds_read_b128 v[164:167], v6 offset:2112
    ds_read_b128 v[168:171], v6 offset:2176
    ds_read_b128 v[172:175], v6 offset:2240
    ds_read_b128 v[176:179], v6 offset:2304
    ds_read_b128 v[180:183], v6 offset:2368
    v_lshlrev_b32 v5, 4, v1
    s_waitcnt lgkmcnt(0)
    v_pk_fma_f32 v[24:25], v[160:161], v[184:185], v[24:25] op_sel_hi:[1,0,1]
    v_pk_fma_f32 v[72:73], v[172:173], v[184:185], v[72:73] op_sel_hi:[1,0,1]
    v_pk_fma_f32 v[26:27], v[162:163], v[184:185], v[26:27] op_sel_hi:[1,0,1]
    v_pk_fma_f32 v[74:75], v[174:175], v[184:185], v[74:75] op_sel_hi:[1,0,1]
    v_pk_mul_f32 v[120:121], v[24:25], v[184:185] op_sel:[0,1] op_sel_hi:[1,1]
    v_pk_mul_f32 v[122:123], v[26:27], v[184:185] op_sel:[0,1] op_sel_hi:[1,1]
    v_exp_f32 v120, v120
    v_exp_f32 v121, v121
    v_exp_f32 v122, v122
    v_exp_f32 v123, v123
    v_pk_mul_f32 v[24:25], v[24:25], v[72:73]
    v_pk_mul_f32 v[26:27], v[26:27], v[74:75]
    v_pk_fma_f32 v[120:121], v[120:121], v[186:187], v[186:187] op_sel_hi:[1,0,0]
    v_pk_fma_f32 v[122:123], v[122:123], v[186:187], v[186:187] op_sel_hi:[1,0,0]
    v_rcp_f32 v120, v120
    v_rcp_f32 v121, v121
    v_rcp_f32 v122, v122
    v_rcp_f32 v123, v123
    s_nop 0
    v_pk_mul_f32 v[24:25], v[24:25], v[120:121]
    v_pk_mul_f32 v[26:27], v[26:27], v[122:123]
    v_cvt_pk_bf16_f32 v144, v24, v25
    v_cvt_pk_bf16_f32 v145, v26, v27
    v_pk_fma_f32 v[40:41], v[164:165], v[184:185], v[40:41] op_sel_hi:[1,0,1]
    v_pk_fma_f32 v[88:89], v[176:177], v[184:185], v[88:89] op_sel_hi:[1,0,1]
    v_pk_fma_f32 v[42:43], v[166:167], v[184:185], v[42:43] op_sel_hi:[1,0,1]
    v_pk_fma_f32 v[90:91], v[178:179], v[184:185], v[90:91] op_sel_hi:[1,0,1]
    v_pk_mul_f32 v[120:121], v[40:41], v[184:185] op_sel:[0,1] op_sel_hi:[1,1]
    v_pk_mul_f32 v[122:123], v[42:43], v[184:185] op_sel:[0,1] op_sel_hi:[1,1]
    v_exp_f32 v120, v120
    v_exp_f32 v121, v121
    v_exp_f32 v122, v122
    v_exp_f32 v123, v123
    v_pk_mul_f32 v[40:41], v[40:41], v[88:89]
    v_pk_mul_f32 v[42:43], v[42:43], v[90:91]
    v_pk_fma_f32 v[120:121], v[120:121], v[186:187], v[186:187] op_sel_hi:[1,0,0]
    v_pk_fma_f32 v[122:123], v[122:123], v[186:187], v[186:187] op_sel_hi:[1,0,0]
    v_rcp_f32 v120, v120
    v_rcp_f32 v121, v121
    v_rcp_f32 v122, v122
    v_rcp_f32 v123, v123
    s_nop 0
    v_pk_mul_f32 v[40:41], v[40:41], v[120:121]
    v_pk_mul_f32 v[42:43], v[42:43], v[122:123]
    v_cvt_pk_bf16_f32 v146, v40, v41
    v_cvt_pk_bf16_f32 v147, v42, v43
    buffer_store_dwordx4 v[144:147], v5, s[32:35], s23 offen offset:0 sc1
    v_pk_fma_f32 v[56:57], v[168:169], v[184:185], v[56:57] op_sel_hi:[1,0,1]
    v_pk_fma_f32 v[104:105], v[180:181], v[184:185], v[104:105] op_sel_hi:[1,0,1]
    v_pk_fma_f32 v[58:59], v[170:171], v[184:185], v[58:59] op_sel_hi:[1,0,1]
    v_pk_fma_f32 v[106:107], v[182:183], v[184:185], v[106:107] op_sel_hi:[1,0,1]
    v_pk_mul_f32 v[120:121], v[56:57], v[184:185] op_sel:[0,1] op_sel_hi:[1,1]
    v_pk_mul_f32 v[122:123], v[58:59], v[184:185] op_sel:[0,1] op_sel_hi:[1,1]
    v_exp_f32 v120, v120
    v_exp_f32 v121, v121
    v_exp_f32 v122, v122
    v_exp_f32 v123, v123
    v_pk_mul_f32 v[56:57], v[56:57], v[104:105]
    v_pk_mul_f32 v[58:59], v[58:59], v[106:107]
    v_pk_fma_f32 v[120:121], v[120:121], v[186:187], v[186:187] op_sel_hi:[1,0,0]
    v_pk_fma_f32 v[122:123], v[122:123], v[186:187], v[186:187] op_sel_hi:[1,0,0]
    v_rcp_f32 v120, v120
    v_rcp_f32 v121, v121
    v_rcp_f32 v122, v122
    v_rcp_f32 v123, v123
    s_nop 0
    v_pk_mul_f32 v[56:57], v[56:57], v[120:121]
    v_pk_mul_f32 v[58:59], v[58:59], v[122:123]
    v_cvt_pk_bf16_f32 v152, v56, v57
    v_cvt_pk_bf16_f32 v153, v58, v59
    v_pk_fma_f32 v[28:29], v[160:161], v[188:189], v[28:29] op_sel_hi:[1,0,1]
    v_pk_fma_f32 v[76:77], v[172:173], v[188:189], v[76:77] op_sel_hi:[1,0,1]
    v_pk_fma_f32 v[30:31], v[162:163], v[188:189], v[30:31] op_sel_hi:[1,0,1]
    v_pk_fma_f32 v[78:79], v[174:175], v[188:189], v[78:79] op_sel_hi:[1,0,1]
    v_pk_mul_f32 v[120:121], v[28:29], v[188:189] op_sel:[0,1] op_sel_hi:[1,1]
    v_pk_mul_f32 v[122:123], v[30:31], v[188:189] op_sel:[0,1] op_sel_hi:[1,1]
    v_exp_f32 v120, v120
    v_exp_f32 v121, v121
    v_exp_f32 v122, v122
    v_exp_f32 v123, v123
    v_pk_mul_f32 v[28:29], v[28:29], v[76:77]
    v_pk_mul_f32 v[30:31], v[30:31], v[78:79]
    v_pk_fma_f32 v[120:121], v[120:121], v[190:191], v[190:191] op_sel_hi:[1,0,0]
    v_pk_fma_f32 v[122:123], v[122:123], v[190:191], v[190:191] op_sel_hi:[1,0,0]
    v_rcp_f32 v120, v120
    v_rcp_f32 v121, v121
    v_rcp_f32 v122, v122
    v_rcp_f32 v123, v123
    s_nop 0
    v_pk_mul_f32 v[28:29], v[28:29], v[120:121]
    v_pk_mul_f32 v[30:31], v[30:31], v[122:123]
    v_cvt_pk_bf16_f32 v148, v28, v29
    v_cvt_pk_bf16_f32 v149, v30, v31
    v_pk_fma_f32 v[44:45], v[164:165], v[188:189], v[44:45] op_sel_hi:[1,0,1]
    v_pk_fma_f32 v[92:93], v[176:177], v[188:189], v[92:93] op_sel_hi:[1,0,1]
    v_pk_fma_f32 v[46:47], v[166:167], v[188:189], v[46:47] op_sel_hi:[1,0,1]
    v_pk_fma_f32 v[94:95], v[178:179], v[188:189], v[94:95] op_sel_hi:[1,0,1]
    v_pk_mul_f32 v[120:121], v[44:45], v[188:189] op_sel:[0,1] op_sel_hi:[1,1]
    v_pk_mul_f32 v[122:123], v[46:47], v[188:189] op_sel:[0,1] op_sel_hi:[1,1]
    v_exp_f32 v120, v120
    v_exp_f32 v121, v121
    v_exp_f32 v122, v122
    v_exp_f32 v123, v123
    v_pk_mul_f32 v[44:45], v[44:45], v[92:93]
    v_pk_mul_f32 v[46:47], v[46:47], v[94:95]
    v_pk_fma_f32 v[120:121], v[120:121], v[190:191], v[190:191] op_sel_hi:[1,0,0]
    v_pk_fma_f32 v[122:123], v[122:123], v[190:191], v[190:191] op_sel_hi:[1,0,0]
    v_rcp_f32 v120, v120
    v_rcp_f32 v121, v121
    v_rcp_f32 v122, v122
    v_rcp_f32 v123, v123
    s_nop 0
    v_pk_mul_f32 v[44:45], v[44:45], v[120:121]
    v_pk_mul_f32 v[46:47], v[46:47], v[122:123]
    v_cvt_pk_bf16_f32 v150, v44, v45
    v_cvt_pk_bf16_f32 v151, v46, v47
    buffer_store_dwordx4 v[148:151], v5, s[32:35], s23 offen offset:1024 sc1
    v_pk_fma_f32 v[60:61], v[168:169], v[188:189], v[60:61] op_sel_hi:[1,0,1]
    v_pk_fma_f32 v[108:109], v[180:181], v[188:189], v[108:109] op_sel_hi:[1,0,1]
    v_pk_fma_f32 v[62:63], v[170:171], v[188:189], v[62:63] op_sel_hi:[1,0,1]
    v_pk_fma_f32 v[110:111], v[182:183], v[188:189], v[110:111] op_sel_hi:[1,0,1]
    v_pk_mul_f32 v[120:121], v[60:61], v[188:189] op_sel:[0,1] op_sel_hi:[1,1]
    v_pk_mul_f32 v[122:123], v[62:63], v[188:189] op_sel:[0,1] op_sel_hi:[1,1]
    v_exp_f32 v120, v120
    v_exp_f32 v121, v121
    v_exp_f32 v122, v122
    v_exp_f32 v123, v123
    v_pk_mul_f32 v[60:61], v[60:61], v[108:109]
    v_pk_mul_f32 v[62:63], v[62:63], v[110:111]
    v_pk_fma_f32 v[120:121], v[120:121], v[190:191], v[190:191] op_sel_hi:[1,0,0]
    v_pk_fma_f32 v[122:123], v[122:123], v[190:191], v[190:191] op_sel_hi:[1,0,0]
    v_rcp_f32 v120, v120
    v_rcp_f32 v121, v121
    v_rcp_f32 v122, v122
    v_rcp_f32 v123, v123
    s_nop 0
    v_pk_mul_f32 v[60:61], v[60:61], v[120:121]
    v_pk_mul_f32 v[62:63], v[62:63], v[122:123]
    v_cvt_pk_bf16_f32 v154, v60, v61
    v_cvt_pk_bf16_f32 v155, v62, v63
    s_nop 1
    v_permlane16_swap_b32 v152, v154
    v_permlane16_swap_b32 v153, v155
    buffer_store_dwordx4 v[152:155], v7, s[32:35], s22 offen offset:0 sc1
    v_pk_fma_f32 v[32:33], v[160:161], v[192:193], v[32:33] op_sel_hi:[1,0,1]
    v_pk_fma_f32 v[80:81], v[172:173], v[192:193], v[80:81] op_sel_hi:[1,0,1]
    v_pk_fma_f32 v[34:35], v[162:163], v[192:193], v[34:35] op_sel_hi:[1,0,1]
    v_pk_fma_f32 v[82:83], v[174:175], v[192:193], v[82:83] op_sel_hi:[1,0,1]
    v_pk_mul_f32 v[120:121], v[32:33], v[192:193] op_sel:[0,1] op_sel_hi:[1,1]
    v_pk_mul_f32 v[122:123], v[34:35], v[192:193] op_sel:[0,1] op_sel_hi:[1,1]
    v_exp_f32 v120, v120
    v_exp_f32 v121, v121
    v_exp_f32 v122, v122
    v_exp_f32 v123, v123
    v_pk_mul_f32 v[32:33], v[32:33], v[80:81]
    v_pk_mul_f32 v[34:35], v[34:35], v[82:83]
    v_pk_fma_f32 v[120:121], v[120:121], v[194:195], v[194:195] op_sel_hi:[1,0,0]
    v_pk_fma_f32 v[122:123], v[122:123], v[194:195], v[194:195] op_sel_hi:[1,0,0]
    v_rcp_f32 v120, v120
    v_rcp_f32 v121, v121
    v_rcp_f32 v122, v122
    v_rcp_f32 v123, v123
    s_nop 0
    v_pk_mul_f32 v[32:33], v[32:33], v[120:121]
    v_pk_mul_f32 v[34:35], v[34:35], v[122:123]
    v_cvt_pk_bf16_f32 v144, v32, v33
    v_cvt_pk_bf16_f32 v145, v34, v35
    v_pk_fma_f32 v[48:49], v[164:165], v[192:193], v[48:49] op_sel_hi:[1,0,1]
    v_pk_fma_f32 v[96:97], v[176:177], v[192:193], v[96:97] op_sel_hi:[1,0,1]
    v_pk_fma_f32 v[50:51], v[166:167], v[192:193], v[50:51] op_sel_hi:[1,0,1]
    v_pk_fma_f32 v[98:99], v[178:179], v[192:193], v[98:99] op_sel_hi:[1,0,1]
    v_pk_mul_f32 v[120:121], v[48:49], v[192:193] op_sel:[0,1] op_sel_hi:[1,1]
    v_pk_mul_f32 v[122:123], v[50:51], v[192:193] op_sel:[0,1] op_sel_hi:[1,1]
    v_exp_f32 v120, v120
    v_exp_f32 v121, v121
    v_exp_f32 v122, v122
    v_exp_f32 v123, v123
    v_pk_mul_f32 v[48:49], v[48:49], v[96:97]
    v_pk_mul_f32 v[50:51], v[50:51], v[98:99]
    v_pk_fma_f32 v[120:121], v[120:121], v[194:195], v[194:195] op_sel_hi:[1,0,0]
    v_pk_fma_f32 v[122:123], v[122:123], v[194:195], v[194:195] op_sel_hi:[1,0,0]
    v_rcp_f32 v120, v120
    v_rcp_f32 v121, v121
    v_rcp_f32 v122, v122
    v_rcp_f32 v123, v123
    s_nop 0
    v_pk_mul_f32 v[48:49], v[48:49], v[120:121]
    v_pk_mul_f32 v[50:51], v[50:51], v[122:123]
    v_cvt_pk_bf16_f32 v146, v48, v49
    v_cvt_pk_bf16_f32 v147, v50, v51
    buffer_store_dwordx4 v[144:147], v5, s[32:35], s23 offen offset:2048 sc1
    v_pk_fma_f32 v[64:65], v[168:169], v[192:193], v[64:65] op_sel_hi:[1,0,1]
    v_pk_fma_f32 v[112:113], v[180:181], v[192:193], v[112:113] op_sel_hi:[1,0,1]
    v_pk_fma_f32 v[66:67], v[170:171], v[192:193], v[66:67] op_sel_hi:[1,0,1]
    v_pk_fma_f32 v[114:115], v[182:183], v[192:193], v[114:115] op_sel_hi:[1,0,1]
    v_pk_mul_f32 v[120:121], v[64:65], v[192:193] op_sel:[0,1] op_sel_hi:[1,1]
    v_pk_mul_f32 v[122:123], v[66:67], v[192:193] op_sel:[0,1] op_sel_hi:[1,1]
    v_exp_f32 v120, v120
    v_exp_f32 v121, v121
    v_exp_f32 v122, v122
    v_exp_f32 v123, v123
    v_pk_mul_f32 v[64:65], v[64:65], v[112:113]
    v_pk_mul_f32 v[66:67], v[66:67], v[114:115]
    v_pk_fma_f32 v[120:121], v[120:121], v[194:195], v[194:195] op_sel_hi:[1,0,0]
    v_pk_fma_f32 v[122:123], v[122:123], v[194:195], v[194:195] op_sel_hi:[1,0,0]
    v_rcp_f32 v120, v120
    v_rcp_f32 v121, v121
    v_rcp_f32 v122, v122
    v_rcp_f32 v123, v123
    s_nop 0
    v_pk_mul_f32 v[64:65], v[64:65], v[120:121]
    v_pk_mul_f32 v[66:67], v[66:67], v[122:123]
    v_cvt_pk_bf16_f32 v156, v64, v65
    v_cvt_pk_bf16_f32 v157, v66, v67
    v_pk_fma_f32 v[36:37], v[160:161], v[196:197], v[36:37] op_sel_hi:[1,0,1]
    v_pk_fma_f32 v[84:85], v[172:173], v[196:197], v[84:85] op_sel_hi:[1,0,1]
    v_pk_fma_f32 v[38:39], v[162:163], v[196:197], v[38:39] op_sel_hi:[1,0,1]
    v_pk_fma_f32 v[86:87], v[174:175], v[196:197], v[86:87] op_sel_hi:[1,0,1]
    v_pk_mul_f32 v[120:121], v[36:37], v[196:197] op_sel:[0,1] op_sel_hi:[1,1]
    v_pk_mul_f32 v[122:123], v[38:39], v[196:197] op_sel:[0,1] op_sel_hi:[1,1]
    v_exp_f32 v120, v120
    v_exp_f32 v121, v121
    v_exp_f32 v122, v122
    v_exp_f32 v123, v123
    v_pk_mul_f32 v[36:37], v[36:37], v[84:85]
    v_pk_mul_f32 v[38:39], v[38:39], v[86:87]
    v_pk_fma_f32 v[120:121], v[120:121], v[198:199], v[198:199] op_sel_hi:[1,0,0]
    v_pk_fma_f32 v[122:123], v[122:123], v[198:199], v[198:199] op_sel_hi:[1,0,0]
    v_rcp_f32 v120, v120
    v_rcp_f32 v121, v121
    v_rcp_f32 v122, v122
    v_rcp_f32 v123, v123
    s_nop 0
    v_pk_mul_f32 v[36:37], v[36:37], v[120:121]
    v_pk_mul_f32 v[38:39], v[38:39], v[122:123]
    v_cvt_pk_bf16_f32 v148, v36, v37
    v_cvt_pk_bf16_f32 v149, v38, v39
    v_pk_fma_f32 v[52:53], v[164:165], v[196:197], v[52:53] op_sel_hi:[1,0,1]
    v_pk_fma_f32 v[100:101], v[176:177], v[196:197], v[100:101] op_sel_hi:[1,0,1]
    v_pk_fma_f32 v[54:55], v[166:167], v[196:197], v[54:55] op_sel_hi:[1,0,1]
    v_pk_fma_f32 v[102:103], v[178:179], v[196:197], v[102:103] op_sel_hi:[1,0,1]
    v_pk_mul_f32 v[120:121], v[52:53], v[196:197] op_sel:[0,1] op_sel_hi:[1,1]
    v_pk_mul_f32 v[122:123], v[54:55], v[196:197] op_sel:[0,1] op_sel_hi:[1,1]
    v_exp_f32 v120, v120
    v_exp_f32 v121, v121
    v_exp_f32 v122, v122
    v_exp_f32 v123, v123
    v_pk_mul_f32 v[52:53], v[52:53], v[100:101]
    v_pk_mul_f32 v[54:55], v[54:55], v[102:103]
    v_pk_fma_f32 v[120:121], v[120:121], v[198:199], v[198:199] op_sel_hi:[1,0,0]
    v_pk_fma_f32 v[122:123], v[122:123], v[198:199], v[198:199] op_sel_hi:[1,0,0]
    v_rcp_f32 v120, v120
    v_rcp_f32 v121, v121
    v_rcp_f32 v122, v122
    v_rcp_f32 v123, v123
    s_nop 0
    v_pk_mul_f32 v[52:53], v[52:53], v[120:121]
    v_pk_mul_f32 v[54:55], v[54:55], v[122:123]
    v_cvt_pk_bf16_f32 v150, v52, v53
    v_cvt_pk_bf16_f32 v151, v54, v55
    buffer_store_dwordx4 v[148:151], v5, s[32:35], s23 offen offset:3072 sc1
    v_pk_fma_f32 v[68:69], v[168:169], v[196:197], v[68:69] op_sel_hi:[1,0,1]
    v_pk_fma_f32 v[116:117], v[180:181], v[196:197], v[116:117] op_sel_hi:[1,0,1]
    v_pk_fma_f32 v[70:71], v[170:171], v[196:197], v[70:71] op_sel_hi:[1,0,1]
    v_pk_fma_f32 v[118:119], v[182:183], v[196:197], v[118:119] op_sel_hi:[1,0,1]
    v_pk_mul_f32 v[120:121], v[68:69], v[196:197] op_sel:[0,1] op_sel_hi:[1,1]
    v_pk_mul_f32 v[122:123], v[70:71], v[196:197] op_sel:[0,1] op_sel_hi:[1,1]
    v_exp_f32 v120, v120
    v_exp_f32 v121, v121
    v_exp_f32 v122, v122
    v_exp_f32 v123, v123
    v_pk_mul_f32 v[68:69], v[68:69], v[116:117]
    v_pk_mul_f32 v[70:71], v[70:71], v[118:119]
    v_pk_fma_f32 v[120:121], v[120:121], v[198:199], v[198:199] op_sel_hi:[1,0,0]
    v_pk_fma_f32 v[122:123], v[122:123], v[198:199], v[198:199] op_sel_hi:[1,0,0]
    v_rcp_f32 v120, v120
    v_rcp_f32 v121, v121
    v_rcp_f32 v122, v122
    v_rcp_f32 v123, v123
    s_nop 0
    v_pk_mul_f32 v[68:69], v[68:69], v[120:121]
    v_pk_mul_f32 v[70:71], v[70:71], v[122:123]
    v_cvt_pk_bf16_f32 v158, v68, v69
    v_cvt_pk_bf16_f32 v159, v70, v71
    s_nop 1
    v_permlane16_swap_b32 v156, v158
    v_permlane16_swap_b32 v157, v159
    buffer_store_dwordx4 v[156:159], v7, s[32:35], s22 offen offset:2048 sc1
    s_lshl_b32 s22, s16, 1
    s_add_u32 s22, s22, s17
    s_lshr_b32 s18, s10, 1
    s_mul_i32 s18, s18, 163840
    s_mul_i32 s19, s11, 20480
    s_add_u32 s18, s18, s19
    s_and_b32 s19, s10, 1
    s_lshl_b32 s19, s19, 7
    s_add_u32 s18, s18, s19
    s_lshl_b32 s19, s22, 5
    s_add_u32 s18, s18, s19
    v_lshlrev_b32 v10, 1, v4
    v_lshl_add_u32 v11, v3, 10, v10
    v_lshl_add_u32 v10, v3, 11, v10
    s_add_u32 s19, s18, 8192
    s_add_u32 s20, s18, 16384
    s_add_u32 s36, s4, 0x700000
    s_addc_u32 s37, s5, 0
    s_mov_b32 s38, 2621440
    s_mov_b32 s39, 0x20000
    s_mov_b32 s40, s30
    s_mov_b32 s41, s31
    s_mov_b32 s42, 2621440
    s_mov_b32 s43, 0x20000
    s_lshl_b32 s21, s8, 4
    s_add_u32 s21, s21, s9
    s_waitcnt vmcnt(0)
    v_mov_b32 v140, 4096
    v_mov_b32 v141, 1
    s_mov_b64 exec, 1
    ds_add_rtn_u32 v141, v140, v141
    s_mov_b64 exec, -1
    s_waitcnt lgkmcnt(0)
    v_readfirstlane_b32 s85, v141
    s_nop 3
    s_cmp_lg_u32 s85, 3
    s_cbranch_scc1 L_notlast_24
    s_mul_i32 s85, s21, 128
    s_add_u32 s85, s85, 65536
    v_mov_b32 v140, s3
    v_mov_b32 v141, s85
    s_mov_b64 exec, 1
    buffer_store_dword v140, v141, s[92:95], 0 offen sc1
    s_mov_b64 exec, -1
L_notlast_24:
    buffer_load_ushort v96, v10, s[36:39], s18 offen offset:0 sc1
    buffer_load_ushort v97, v10, s[36:39], s18 offen offset:256 sc1
    buffer_load_ushort v98, v10, s[36:39], s18 offen offset:512 sc1
    buffer_load_ushort v99, v10, s[36:39], s18 offen offset:768 sc1
    buffer_load_ushort v100, v10, s[36:39], s18 offen offset:1024 sc1
    buffer_load_ushort v101, v10, s[36:39], s18 offen offset:1280 sc1
    buffer_load_ushort v102, v10, s[36:39], s18 offen offset:1536 sc1
    buffer_load_ushort v103, v10, s[36:39], s18 offen offset:1792 sc1
    buffer_load_ushort v104, v10, s[36:39], s19 offen offset:0 sc1
    buffer_load_ushort v105, v10, s[36:39], s19 offen offset:256 sc1
    buffer_load_ushort v106, v10, s[36:39], s19 offen offset:512 sc1
    buffer_load_ushort v107, v10, s[36:39], s19 offen offset:768 sc1
    buffer_load_ushort v108, v10, s[36:39], s19 offen offset:1024 sc1
    buffer_load_ushort v109, v10, s[36:39], s19 offen offset:1280 sc1
    buffer_load_ushort v110, v10, s[36:39], s19 offen offset:1536 sc1
    buffer_load_ushort v111, v10, s[36:39], s19 offen offset:1792 sc1
    buffer_load_ushort v112, v11, s[36:39], s20 offen offset:0 sc1
    buffer_load_ushort v113, v11, s[36:39], s20 offen offset:256 sc1
    buffer_load_ushort v114, v11, s[36:39], s20 offen offset:512 sc1
    buffer_load_ushort v115, v11, s[36:39], s20 offen offset:768 sc1
    v_mov_b32 v16, 0
    v_mov_b32 v17, 0
    v_mov_b32 v18, 0
    v_mov_b32 v19, 0
    v_mov_b32 v20, 0
    v_mov_b32 v21, 0
    v_mov_b32 v22, 0
    v_mov_b32 v23, 0
    v_mov_b32 v24, 0
    v_mov_b32 v25, 0
    v_mov_b32 v26, 0
    v_mov_b32 v27, 0
    v_mov_b32 v28, 0
    v_mov_b32 v29, 0
    v_mov_b32 v30, 0
    v_mov_b32 v31, 0
    v_mov_b32 v32, 0
    v_mov_b32 v33, 0
    v_mov_b32 v34, 0
    v_mov_b32 v35, 0
    v_mov_b32 v36, 0
    v_mov_b32 v37, 0
    v_mov_b32 v38, 0
    v_mov_b32 v39, 0
    v_mov_b32 v40, 0
    v_mov_b32 v41, 0
    v_mov_b32 v42, 0
    v_mov_b32 v43, 0
    v_mov_b32 v44, 0
    v_mov_b32 v45, 0
    v_mov_b32 v46, 0
    v_mov_b32 v47, 0
    v_mov_b32 v48, 0
    v_mov_b32 v49, 0
    v_mov_b32 v50, 0
    v_mov_b32 v51, 0
    v_mov_b32 v52, 0
    v_mov_b32 v53, 0
    v_mov_b32 v54, 0
    v_mov_b32 v55, 0
    s_lshl_b32 s19, s17, 12
    s_lshl_b32 s21, s22, 10
    s_add_u32 s19, s19, s21
    v_add_u32 v120, s19, v5
    v_xor_b32 v121, 1024, v120
    s_mul_i32 s19, s17, 5120
    v_add_u32 v116, s19, v5
    v_add_u32 v117, 61440, v116
    v_add_u32 v118, 122880, v116
    s_lshl_b32 s18, s10, 6
    s_lshl_b32 s19, s22, 4
    s_add_u32 s18, s18, s19
    s_mul_i32 s18, s18, 1280
    s_mul_i32 s19, s11, 160
    s_add_u32 s18, s18, s19
    v_mul_u32_u24 v10, 1280, v4
    v_lshl_add_u32 v11, v3, 3, v10
    v_lshl_add_u32 v10, v3, 4, v10
    s_mul_i32 s19, s7, 5120
    s_add_u32 s19, s19, 87040
    v_add_u32 v6, s19, v5
    s_xor_b32 s19, s7, 2
    s_mul_i32 s19, s19, 5120
    s_add_u32 s19, s19, 87040
    v_add_u32 v7, s19, v5
    s_mul_i32 s24, s10, 196608
    s_add_u32 s25, s24, 196608
    s_mul_i32 s23, s15, 0
    s_add_u32 s23, s23, s24
    s_cmp_lg_u32 s6, 0
    s_cbranch_scc1 L_nopub_25
    s_lshr_b32 s21, s10, 1
    s_mul_i32 s21, s21, 2048
    v_add_u32 v140, 0, v1
    v_min_u32 v140, 15, v140
    v_mul_u32_u24 v140, 128, v140
    s_add_u32 s86, s21, 65536
    s_mov_b32 s84, 0
L_poll_26:
    buffer_load_dword v141, v140, s[92:95], s86 offen sc1
    s_waitcnt vmcnt(0)
    v_xor_b32 v141, s3, v141
    v_cmp_ne_u32 vcc, 0, v141
    s_cbranch_vccz L_polld_27
    s_sleep 3
    s_add_u32 s84, s84, 1
    s_cmp_lt_u32 s84, 400000
    s_cbranch_scc1 L_poll_26
L_polld_27:
L_nopub_25:
    s_barrier
    ds_read_b128 v[56:59], v116 offset:5120
    ds_read_b128 v[60:63], v116 offset:6144
    ds_read_b128 v[64:67], v116 offset:7168
    ds_read_b128 v[68:71], v116 offset:8192
    ds_read_b128 v[72:75], v116 offset:9216
    buffer_load_dwordx4 v[144:147], v120, s[32:35], s23 offen sc1
    buffer_load_dwordx4 v[148:151], v121, s[32:35], s23 offen sc1
    s_add_u32 s23, s23, 8192
    buffer_load_dwordx4 v[152:155], v120, s[32:35], s23 offen sc1
    buffer_load_dwordx4 v[156:159], v121, s[32:35], s23 offen sc1
    s_add_u32 s23, s23, 8192
    buffer_load_dwordx4 v[160:163], v120, s[32:35], s23 offen sc1
    buffer_load_dwordx4 v[164:167], v121, s[32:35], s23 offen sc1
    s_add_u32 s23, s23, 8192
    s_waitcnt vmcnt(4)
    s_waitcnt lgkmcnt(0)
    v_mfma_f32_16x16x32_bf16 v[16:19], v[56:59], v[144:147], v[16:19]
    ds_read_b128 v[76:79], v116 offset:15360
    v_mfma_f32_16x16x32_bf16 v[36:39], v[56:59], v[148:151], v[36:39]
    ds_read_b128 v[80:83], v116 offset:16384
    v_mfma_f32_16x16x32_bf16 v[20:23], v[60:63], v[144:147], v[20:23]
    ds_read_b128 v[84:87], v116 offset:17408
    v_mfma_f32_16x16x32_bf16 v[40:43], v[60:63], v[148:151], v[40:43]
    ds_read_b128 v[88:91], v116 offset:18432
    v_mfma_f32_16x16x32_bf16 v[24:27], v[64:67], v[144:147], v[24:27]
    ds_read_b128 v[92:95], v116 offset:19456
    v_mfma_f32_16x16x32_bf16 v[44:47], v[64:67], v[148:151], v[44:47]
    buffer_load_dwordx4 v[168:171], v120, s[32:35], s23 offen sc1
    v_mfma_f32_16x16x32_bf16 v[28:31], v[68:71], v[144:147], v[28:31]
    buffer_load_dwordx4 v[172:175], v121, s[32:35], s23 offen sc1
    v_mfma_f32_16x16x32_bf16 v[48:51], v[68:71], v[148:151], v[48:51]
    s_add_u32 s23, s23, 8192
    v_mfma_f32_16x16x32_bf16 v[32:35], v[72:75], v[144:147], v[32:35]
    buffer_load_dwordx4 v[176:179], v120, s[32:35], s23 offen sc1
    v_mfma_f32_16x16x32_bf16 v[52:55], v[72:75], v[148:151], v[52:55]
    buffer_load_dwordx4 v[180:183], v121, s[32:35], s23 offen sc1
    s_add_u32 s23, s23, 8192
    buffer_load_dwordx4 v[184:187], v120, s[32:35], s23 offen sc1
    buffer_load_dwordx4 v[188:191], v121, s[32:35], s23 offen sc1
    s_add_u32 s23, s23, 8192
    s_waitcnt vmcnt(8)
    s_waitcnt lgkmcnt(0)
    v_mfma_f32_16x16x32_bf16 v[16:19], v[76:79], v[152:155], v[16:19]
    ds_read_b128 v[56:59], v116 offset:25600
    v_mfma_f32_16x16x32_bf16 v[36:39], v[76:79], v[156:159], v[36:39]
    ds_read_b128 v[60:63], v116 offset:26624
    v_mfma_f32_16x16x32_bf16 v[20:23], v[80:83], v[152:155], v[20:23]
    ds_read_b128 v[64:67], v116 offset:27648
    v_mfma_f32_16x16x32_bf16 v[40:43], v[80:83], v[156:159], v[40:43]
    ds_read_b128 v[68:71], v116 offset:28672
    v_mfma_f32_16x16x32_bf16 v[24:27], v[84:87], v[152:155], v[24:27]
    ds_read_b128 v[72:75], v116 offset:29696
    v_mfma_f32_16x16x32_bf16 v[44:47], v[84:87], v[156:159], v[44:47]
    buffer_load_dwordx4 v[192:195], v120, s[32:35], s23 offen sc1
    v_mfma_f32_16x16x32_bf16 v[28:31], v[88:91], v[152:155], v[28:31]
    buffer_load_dwordx4 v[196:199], v121, s[32:35], s23 offen sc1
    v_mfma_f32_16x16x32_bf16 v[48:51], v[88:91], v[156:159], v[48:51]
    s_add_u32 s23, s23, 8192
    v_mfma_f32_16x16x32_bf16 v[32:35], v[92:95], v[152:155], v[32:35]
    buffer_load_dwordx4 v[200:203], v120, s[32:35], s23 offen sc1
    v_mfma_f32_16x16x32_bf16 v[52:55], v[92:95], v[156:159], v[52:55]
    buffer_load_dwordx4 v[204:207], v121, s[32:35], s23 offen sc1
    s_add_u32 s23, s23, 8192
    buffer_load_dwordx4 v[208:211], v120, s[32:35], s23 offen sc1
    buffer_load_dwordx4 v[212:215], v121, s[32:35], s23 offen sc1
    s_add_u32 s23, s23, 8192
    s_waitcnt vmcnt(12)
    s_waitcnt lgkmcnt(0)
    v_mfma_f32_16x16x32_bf16 v[16:19], v[56:59], v[160:163], v[16:19]
    ds_read_b128 v[76:79], v116 offset:35840
    v_mfma_f32_16x16x32_bf16 v[36:39], v[56:59], v[164:167], v[36:39]
    ds_read_b128 v[80:83], v116 offset:36864
    v_mfma_f32_16x16x32_bf16 v[20:23], v[60:63], v[160:163], v[20:23]
    ds_read_b128 v[84:87], v116 offset:37888
    v_mfma_f32_16x16x32_bf16 v[40:43], v[60:63], v[164:167], v[40:43]
    ds_read_b128 v[88:91], v116 offset:38912
    v_mfma_f32_16x16x32_bf16 v[24:27], v[64:67], v[160:163], v[24:27]
    ds_read_b128 v[92:95], v116 offset:39936
    v_mfma_f32_16x16x32_bf16 v[44:47], v[64:67], v[164:167], v[44:47]
    buffer_load_dwordx4 v[216:219], v120, s[32:35], s23 offen sc1
    v_mfma_f32_16x16x32_bf16 v[28:31], v[68:71], v[160:163], v[28:31]
    buffer_load_dwordx4 v[220:223], v121, s[32:35], s23 offen sc1
    v_mfma_f32_16x16x32_bf16 v[48:51], v[68:71], v[164:167], v[48:51]
    s_add_u32 s23, s23, 8192
    v_mfma_f32_16x16x32_bf16 v[32:35], v[72:75], v[160:163], v[32:35]
    buffer_load_dwordx4 v[224:227], v120, s[32:35], s23 offen sc1
    v_mfma_f32_16x16x32_bf16 v[52:55], v[72:75], v[164:167], v[52:55]
    buffer_load_dwordx4 v[228:231], v121, s[32:35], s23 offen sc1
    s_add_u32 s23, s23, 8192
    buffer_load_dwordx4 v[232:235], v120, s[32:35], s23 offen sc1
    buffer_load_dwordx4 v[236:239], v121, s[32:35], s23 offen sc1
    s_add_u32 s23, s23, 8192
    s_waitcnt vmcnt(16)
    s_waitcnt lgkmcnt(0)
    v_mfma_f32_16x16x32_bf16 v[16:19], v[76:79], v[168:171], v[16:19]
    ds_read_b128 v[56:59], v116 offset:46080
    v_mfma_f32_16x16x32_bf16 v[36:39], v[76:79], v[172:175], v[36:39]
    ds_read_b128 v[60:63], v116 offset:47104
    v_mfma_f32_16x16x32_bf16 v[20:23], v[80:83], v[168:171], v[20:23]
    ds_read_b128 v[64:67], v116 offset:48128
    v_mfma_f32_16x16x32_bf16 v[40:43], v[80:83], v[172:175], v[40:43]
    ds_read_b128 v[68:71], v116 offset:49152
    v_mfma_f32_16x16x32_bf16 v[24:27], v[84:87], v[168:171], v[24:27]
    ds_read_b128 v[72:75], v116 offset:50176
    v_mfma_f32_16x16x32_bf16 v[44:47], v[84:87], v[172:175], v[44:47]
    buffer_load_dwordx4 v[144:147], v120, s[32:35], s23 offen sc1
    v_mfma_f32_16x16x32_bf16 v[28:31], v[88:91], v[168:171], v[28:31]
    buffer_load_dwordx4 v[148:151], v121, s[32:35], s23 offen sc1
    v_mfma_f32_16x16x32_bf16 v[48:51], v[88:91], v[172:175], v[48:51]
    s_add_u32 s23, s23, 8192
    v_mfma_f32_16x16x32_bf16 v[32:35], v[92:95], v[168:171], v[32:35]
    buffer_load_dwordx4 v[152:155], v120, s[32:35], s23 offen sc1
    v_mfma_f32_16x16x32_bf16 v[52:55], v[92:95], v[172:175], v[52:55]
    buffer_load_dwordx4 v[156:159], v121, s[32:35], s23 offen sc1
    s_add_u32 s23, s23, 8192
    buffer_load_dwordx4 v[160:163], v120, s[32:35], s23 offen sc1
    buffer_load_dwordx4 v[164:167], v121, s[32:35], s23 offen sc1
    s_add_u32 s23, s23, 8192
    s_waitcnt vmcnt(20)
    s_waitcnt lgkmcnt(0)
    v_mfma_f32_16x16x32_bf16 v[16:19], v[56:59], v[176:179], v[16:19]
    ds_read_b128 v[76:79], v116 offset:56320
    v_mfma_f32_16x16x32_bf16 v[36:39], v[56:59], v[180:183], v[36:39]
    ds_read_b128 v[80:83], v116 offset:57344
    v_mfma_f32_16x16x32_bf16 v[20:23], v[60:63], v[176:179], v[20:23]
    ds_read_b128 v[84:87], v116 offset:58368
    v_mfma_f32_16x16x32_bf16 v[40:43], v[60:63], v[180:183], v[40:43]
    ds_read_b128 v[88:91], v116 offset:59392
    v_mfma_f32_16x16x32_bf16 v[24:27], v[64:67], v[176:179], v[24:27]
    ds_read_b128 v[92:95], v116 offset:60416
    v_mfma_f32_16x16x32_bf16 v[44:47], v[64:67], v[180:183], v[44:47]
    buffer_load_dwordx4 v[168:171], v120, s[32:35], s23 offen sc1
    v_mfma_f32_16x16x32_bf16 v[28:31], v[68:71], v[176:179], v[28:31]
    buffer_load_dwordx4 v[172:175], v121, s[32:35], s23 offen sc1
    v_mfma_f32_16x16x32_bf16 v[48:51], v[68:71], v[180:183], v[48:51]
    s_add_u32 s23, s23, 8192
    v_mfma_f32_16x16x32_bf16 v[32:35], v[72:75], v[176:179], v[32:35]
    v_mfma_f32_16x16x32_bf16 v[52:55], v[72:75], v[180:183], v[52:55]
    s_waitcnt vmcnt(20)
    s_waitcnt lgkmcnt(0)
    s_barrier
    v_mfma_f32_16x16x32_bf16 v[16:19], v[76:79], v[184:187], v[16:19]
    ds_read_b128 v[56:59], v118 offset:5120
    v_mfma_f32_16x16x32_bf16 v[36:39], v[76:79], v[188:191], v[36:39]
    ds_read_b128 v[60:63], v118 offset:6144
    v_mfma_f32_16x16x32_bf16 v[20:23], v[80:83], v[184:187], v[20:23]
    ds_read_b128 v[64:67], v118 offset:7168
    v_mfma_f32_16x16x32_bf16 v[40:43], v[80:83], v[188:191], v[40:43]
    ds_read_b128 v[68:71], v118 offset:8192
    v_mfma_f32_16x16x32_bf16 v[24:27], v[84:87], v[184:187], v[24:27]
    ds_read_b128 v[72:75], v118 offset:9216
    v_mfma_f32_16x16x32_bf16 v[44:47], v[84:87], v[188:191], v[44:47]
    buffer_load_dwordx4 v[176:179], v120, s[32:35], s23 offen sc1
    v_mfma_f32_16x16x32_bf16 v[28:31], v[88:91], v[184:187], v[28:31]
    buffer_load_dwordx4 v[180:183], v121, s[32:35], s23 offen sc1
    v_mfma_f32_16x16x32_bf16 v[48:51], v[88:91], v[188:191], v[48:51]
    s_add_u32 s23, s23, 8192
    v_mfma_f32_16x16x32_bf16 v[32:35], v[92:95], v[184:187], v[32:35]
    v_mfma_f32_16x16x32_bf16 v[52:55], v[92:95], v[188:191], v[52:55]
    s_waitcnt vmcnt(20)
    s_waitcnt lgkmcnt(0)
    v_mfma_f32_16x16x32_bf16 v[16:19], v[56:59], v[192:195], v[16:19]
    ds_read_b128 v[76:79], v118 offset:15360
    v_mfma_f32_16x16x32_bf16 v[36:39], v[56:59], v[196:199], v[36:39]
    ds_read_b128 v[80:83], v118 offset:16384
    v_mfma_f32_16x16x32_bf16 v[20:23], v[60:63], v[192:195], v[20:23]
    ds_read_b128 v[84:87], v118 offset:17408
    v_mfma_f32_16x16x32_bf16 v[40:43], v[60:63], v[196:199], v[40:43]
    ds_read_b128 v[88:91], v118 offset:18432
    v_mfma_f32_16x16x32_bf16 v[24:27], v[64:67], v[192:195], v[24:27]
    ds_read_b128 v[92:95], v118 offset:19456
    v_mfma_f32_16x16x32_bf16 v[44:47], v[64:67], v[196:199], v[44:47]
    buffer_load_dwordx4 v[184:187], v120, s[32:35], s23 offen sc1
    v_mfma_f32_16x16x32_bf16 v[28:31], v[68:71], v[192:195], v[28:31]
    buffer_load_dwordx4 v[188:191], v121, s[32:35], s23 offen sc1
    v_mfma_f32_16x16x32_bf16 v[48:51], v[68:71], v[196:199], v[48:51]
    s_add_u32 s23, s23, 8192
    v_mfma_f32_16x16x32_bf16 v[32:35], v[72:75], v[192:195], v[32:35]
    v_mfma_f32_16x16x32_bf16 v[52:55], v[72:75], v[196:199], v[52:55]
    s_waitcnt vmcnt(20)
    s_waitcnt lgkmcnt(0)
    v_mfma_f32_16x16x32_bf16 v[16:19], v[76:79], v[200:203], v[16:19]
    ds_read_b128 v[56:59], v117 offset:5120
    v_mfma_f32_16x16x32_bf16 v[36:39], v[76:79], v[204:207], v[36:39]
    ds_read_b128 v[60:63], v117 offset:6144
    v_mfma_f32_16x16x32_bf16 v[20:23], v[80:83], v[200:203], v[20:23]
    ds_read_b128 v[64:67], v117 offset:7168
    v_mfma_f32_16x16x32_bf16 v[40:43], v[80:83], v[204:207], v[40:43]
    ds_read_b128 v[68:71], v117 offset:8192
    v_mfma_f32_16x16x32_bf16 v[24:27], v[84:87], v[200:203], v[24:27]
    ds_read_b128 v[72:75], v117 offset:9216
    v_mfma_f32_16x16x32_bf16 v[44:47], v[84:87], v[204:207], v[44:47]
    buffer_load_dwordx4 v[192:195], v120, s[32:35], s23 offen sc1
    v_mfma_f32_16x16x32_bf16 v[28:31], v[88:91], v[200:203], v[28:31]
    buffer_load_dwordx4 v[196:199], v121, s[32:35], s23 offen sc1
    v_mfma_f32_16x16x32_bf16 v[48:51], v[88:91], v[204:207], v[48:51]
    s_add_u32 s23, s23, 8192
    v_mfma_f32_16x16x32_bf16 v[32:35], v[92:95], v[200:203], v[32:35]
    v_mfma_f32_16x16x32_bf16 v[52:55], v[92:95], v[204:207], v[52:55]
    s_waitcnt vmcnt(20)
    s_waitcnt lgkmcnt(0)
    v_mfma_f32_16x16x32_bf16 v[16:19], v[56:59], v[208:211], v[16:19]
    ds_read_b128 v[76:79], v117 offset:15360
    v_mfma_f32_16x16x32_bf16 v[36:39], v[56:59], v[212:215], v[36:39]
    ds_read_b128 v[80:83], v117 offset:16384
    v_mfma_f32_16x16x32_bf16 v[20:23], v[60:63], v[208:211], v[20:23]
    ds_read_b128 v[84:87], v117 offset:17408
    v_mfma_f32_16x16x32_bf16 v[40:43], v[60:63], v[212:215], v[40:43]
    ds_read_b128 v[88:91], v117 offset:18432
    v_mfma_f32_16x16x32_bf16 v[24:27], v[64:67], v[208:211], v[24:27]
    ds_read_b128 v[92:95], v117 offset:19456
    v_mfma_f32_16x16x32_bf16 v[44:47], v[64:67], v[212:215], v[44:47]
    buffer_load_dwordx4 v[200:203], v120, s[32:35], s23 offen sc1
    v_mfma_f32_16x16x32_bf16 v[28:31], v[68:71], v[208:211], v[28:31]
    buffer_load_dwordx4 v[204:207], v121, s[32:35], s23 offen sc1
    v_mfma_f32_16x16x32_bf16 v[48:51], v[68:71], v[212:215], v[48:51]
    s_add_u32 s23, s23, 8192
    v_mfma_f32_16x16x32_bf16 v[32:35], v[72:75], v[208:211], v[32:35]
    v_mfma_f32_16x16x32_bf16 v[52:55], v[72:75], v[212:215], v[52:55]
    s_waitcnt vmcnt(20)
    s_waitcnt lgkmcnt(0)
    s_barrier
    v_mfma_f32_16x16x32_bf16 v[16:19], v[76:79], v[216:219], v[16:19]
    ds_read_b128 v[56:59], v117 offset:25600
    v_mfma_f32_16x16x32_bf16 v[36:39], v[76:79], v[220:223], v[36:39]
    ds_read_b128 v[60:63], v117 offset:26624
    v_mfma_f32_16x16x32_bf16 v[20:23], v[80:83], v[216:219], v[20:23]
    ds_read_b128 v[64:67], v117 offset:27648
    v_mfma_f32_16x16x32_bf16 v[40:43], v[80:83], v[220:223], v[40:43]
    ds_read_b128 v[68:71], v117 offset:28672
    v_mfma_f32_16x16x32_bf16 v[24:27], v[84:87], v[216:219], v[24:27]
    ds_read_b128 v[72:75], v117 offset:29696
    v_mfma_f32_16x16x32_bf16 v[44:47], v[84:87], v[220:223], v[44:47]
    buffer_load_dwordx4 v[208:211], v120, s[32:35], s23 offen sc1
    v_mfma_f32_16x16x32_bf16 v[28:31], v[88:91], v[216:219], v[28:31]
    buffer_load_dwordx4 v[212:215], v121, s[32:35], s23 offen sc1
    v_mfma_f32_16x16x32_bf16 v[48:51], v[88:91], v[220:223], v[48:51]
    s_add_u32 s23, s23, 8192
    v_mfma_f32_16x16x32_bf16 v[32:35], v[92:95], v[216:219], v[32:35]
    v_mfma_f32_16x16x32_bf16 v[52:55], v[92:95], v[220:223], v[52:55]
    s_waitcnt vmcnt(20)
    s_waitcnt lgkmcnt(0)
    v_mfma_f32_16x16x32_bf16 v[16:19], v[56:59], v[224:227], v[16:19]
    ds_read_b128 v[76:79], v117 offset:35840
    v_mfma_f32_16x16x32_bf16 v[36:39], v[56:59], v[228:231], v[36:39]
    ds_read_b128 v[80:83], v117 offset:36864
    v_mfma_f32_16x16x32_bf16 v[20:23], v[60:63], v[224:227], v[20:23]
    ds_read_b128 v[84:87], v117 offset:37888
    v_mfma_f32_16x16x32_bf16 v[40:43], v[60:63], v[228:231], v[40:43]
    ds_read_b128 v[88:91], v117 offset:38912
    v_mfma_f32_16x16x32_bf16 v[24:27], v[64:67], v[224:227], v[24:27]
    ds_read_b128 v[92:95], v117 offset:39936
    v_mfma_f32_16x16x32_bf16 v[44:47], v[64:67], v[228:231], v[44:47]
    buffer_load_dwordx4 v[216:219], v120, s[32:35], s23 offen sc1
    v_mfma_f32_16x16x32_bf16 v[28:31], v[68:71], v[224:227], v[28:31]
    buffer_load_dwordx4 v[220:223], v121, s[32:35], s23 offen sc1
    v_mfma_f32_16x16x32_bf16 v[48:51], v[68:71], v[228:231], v[48:51]
    s_add_u32 s23, s23, 8192
    v_mfma_f32_16x16x32_bf16 v[32:35], v[72:75], v[224:227], v[32:35]
    v_mfma_f32_16x16x32_bf16 v[52:55], v[72:75], v[228:231], v[52:55]
    s_waitcnt vmcnt(20)
    s_waitcnt lgkmcnt(0)
    v_mfma_f32_16x16x32_bf16 v[16:19], v[76:79], v[232:235], v[16:19]
    ds_read_b128 v[56:59], v117 offset:46080
    v_mfma_f32_16x16x32_bf16 v[36:39], v[76:79], v[236:239], v[36:39]
    ds_read_b128 v[60:63], v117 offset:47104
    v_mfma_f32_16x16x32_bf16 v[20:23], v[80:83], v[232:235], v[20:23]
    ds_read_b128 v[64:67], v117 offset:48128
    v_mfma_f32_16x16x32_bf16 v[40:43], v[80:83], v[236:239], v[40:43]
    ds_read_b128 v[68:71], v117 offset:49152
    v_mfma_f32_16x16x32_bf16 v[24:27], v[84:87], v[232:235], v[24:27]
    ds_read_b128 v[72:75], v117 offset:50176
    v_mfma_f32_16x16x32_bf16 v[44:47], v[84:87], v[236:239], v[44:47]
    buffer_load_dwordx4 v[224:227], v120, s[32:35], s23 offen sc1
    v_mfma_f32_16x16x32_bf16 v[28:31], v[88:91], v[232:235], v[28:31]
    buffer_load_dwordx4 v[228:231], v121, s[32:35], s23 offen sc1
    v_mfma_f32_16x16x32_bf16 v[48:51], v[88:91], v[236:239], v[48:51]
    s_add_u32 s23, s23, 8192
    v_mfma_f32_16x16x32_bf16 v[32:35], v[92:95], v[232:235], v[32:35]
    v_mfma_f32_16x16x32_bf16 v[52:55], v[92:95], v[236:239], v[52:55]
    s_waitcnt vmcnt(20)
    s_waitcnt lgkmcnt(0)
    v_mfma_f32_16x16x32_bf16 v[16:19], v[56:59], v[144:147], v[16:19]
    ds_read_b128 v[76:79], v117 offset:56320
    v_mfma_f32_16x16x32_bf16 v[36:39], v[56:59], v[148:151], v[36:39]
    ds_read_b128 v[80:83], v117 offset:57344
    v_mfma_f32_16x16x32_bf16 v[20:23], v[60:63], v[144:147], v[20:23]
    ds_read_b128 v[84:87], v117 offset:58368
    v_mfma_f32_16x16x32_bf16 v[40:43], v[60:63], v[148:151], v[40:43]
    ds_read_b128 v[88:91], v117 offset:59392
    v_mfma_f32_16x16x32_bf16 v[24:27], v[64:67], v[144:147], v[24:27]
    ds_read_b128 v[92:95], v117 offset:60416
    v_mfma_f32_16x16x32_bf16 v[44:47], v[64:67], v[148:151], v[44:47]
    buffer_load_dwordx4 v[232:235], v120, s[32:35], s23 offen sc1
    v_mfma_f32_16x16x32_bf16 v[28:31], v[68:71], v[144:147], v[28:31]
    buffer_load_dwordx4 v[236:239], v121, s[32:35], s23 offen sc1
    v_mfma_f32_16x16x32_bf16 v[48:51], v[68:71], v[148:151], v[48:51]
    s_add_u32 s23, s23, 8192
    v_mfma_f32_16x16x32_bf16 v[32:35], v[72:75], v[144:147], v[32:35]
    v_mfma_f32_16x16x32_bf16 v[52:55], v[72:75], v[148:151], v[52:55]
    s_waitcnt vmcnt(20)
    s_waitcnt lgkmcnt(0)
    s_barrier
    v_mfma_f32_16x16x32_bf16 v[16:19], v[76:79], v[152:155], v[16:19]
    ds_read_b128 v[56:59], v116 offset:5120
    v_mfma_f32_16x16x32_bf16 v[36:39], v[76:79], v[156:159], v[36:39]
    ds_read_b128 v[60:63], v116 offset:6144
    v_mfma_f32_16x16x32_bf16 v[20:23], v[80:83], v[152:155], v[20:23]
    ds_read_b128 v[64:67], v116 offset:7168
    v_mfma_f32_16x16x32_bf16 v[40:43], v[80:83], v[156:159], v[40:43]
    ds_read_b128 v[68:71], v116 offset:8192
    v_mfma_f32_16x16x32_bf16 v[24:27], v[84:87], v[152:155], v[24:27]
    ds_read_b128 v[72:75], v116 offset:9216
    v_mfma_f32_16x16x32_bf16 v[44:47], v[84:87], v[156:159], v[44:47]
    v_mfma_f32_16x16x32_bf16 v[28:31], v[88:91], v[152:155], v[28:31]
    v_mfma_f32_16x16x32_bf16 v[48:51], v[88:91], v[156:159], v[48:51]
    v_mfma_f32_16x16x32_bf16 v[32:35], v[92:95], v[152:155], v[32:35]
    v_mfma_f32_16x16x32_bf16 v[52:55], v[92:95], v[156:159], v[52:55]
    s_waitcnt vmcnt(18)
    s_waitcnt lgkmcnt(0)
    v_mfma_f32_16x16x32_bf16 v[16:19], v[56:59], v[160:163], v[16:19]
    ds_read_b128 v[76:79], v116 offset:15360
    v_mfma_f32_16x16x32_bf16 v[36:39], v[56:59], v[164:167], v[36:39]
    ds_read_b128 v[80:83], v116 offset:16384
    v_mfma_f32_16x16x32_bf16 v[20:23], v[60:63], v[160:163], v[20:23]
    ds_read_b128 v[84:87], v116 offset:17408
    v_mfma_f32_16x16x32_bf16 v[40:43], v[60:63], v[164:167], v[40:43]
    ds_read_b128 v[88:91], v116 offset:18432
    v_mfma_f32_16x16x32_bf16 v[24:27], v[64:67], v[160:163], v[24:27]
    ds_read_b128 v[92:95], v116 offset:19456
    v_mfma_f32_16x16x32_bf16 v[44:47], v[64:67], v[164:167], v[44:47]
    v_mfma_f32_16x16x32_bf16 v[28:31], v[68:71], v[160:163], v[28:31]
    v_mfma_f32_16x16x32_bf16 v[48:51], v[68:71], v[164:167], v[48:51]
    v_mfma_f32_16x16x32_bf16 v[32:35], v[72:75], v[160:163], v[32:35]
    v_mfma_f32_16x16x32_bf16 v[52:55], v[72:75], v[164:167], v[52:55]
    s_waitcnt vmcnt(16)
    s_waitcnt lgkmcnt(0)
    v_mfma_f32_16x16x32_bf16 v[16:19], v[76:79], v[168:171], v[16:19]
    ds_read_b128 v[56:59], v116 offset:25600
    v_mfma_f32_16x16x32_bf16 v[36:39], v[76:79], v[172:175], v[36:39]
    ds_read_b128 v[60:63], v116 offset:26624
    v_mfma_f32_16x16x32_bf16 v[20:23], v[80:83], v[168:171], v[20:23]
    ds_read_b128 v[64:67], v116 offset:27648
    v_mfma_f32_16x16x32_bf16 v[40:43], v[80:83], v[172:175], v[40:43]
    ds_read_b128 v[68:71], v116 offset:28672
    v_mfma_f32_16x16x32_bf16 v[24:27], v[84:87], v[168:171], v[24:27]
    ds_read_b128 v[72:75], v116 offset:29696
    v_mfma_f32_16x16x32_bf16 v[44:47], v[84:87], v[172:175], v[44:47]
    v_mfma_f32_16x16x32_bf16 v[28:31], v[88:91], v[168:171], v[28:31]
    v_mfma_f32_16x16x32_bf16 v[48:51], v[88:91], v[172:175], v[48:51]
    v_mfma_f32_16x16x32_bf16 v[32:35], v[92:95], v[168:171], v[32:35]
    v_mfma_f32_16x16x32_bf16 v[52:55], v[92:95], v[172:175], v[52:55]
    s_waitcnt vmcnt(14)
    s_waitcnt lgkmcnt(0)
    v_mfma_f32_16x16x32_bf16 v[16:19], v[56:59], v[176:179], v[16:19]
    ds_read_b128 v[76:79], v116 offset:35840
    v_mfma_f32_16x16x32_bf16 v[36:39], v[56:59], v[180:183], v[36:39]
    ds_read_b128 v[80:83], v116 offset:36864
    v_mfma_f32_16x16x32_bf16 v[20:23], v[60:63], v[176:179], v[20:23]
    ds_read_b128 v[84:87], v116 offset:37888
    v_mfma_f32_16x16x32_bf16 v[40:43], v[60:63], v[180:183], v[40:43]
    ds_read_b128 v[88:91], v116 offset:38912
    v_mfma_f32_16x16x32_bf16 v[24:27], v[64:67], v[176:179], v[24:27]
    ds_read_b128 v[92:95], v116 offset:39936
    v_mfma_f32_16x16x32_bf16 v[44:47], v[64:67], v[180:183], v[44:47]
    v_mfma_f32_16x16x32_bf16 v[28:31], v[68:71], v[176:179], v[28:31]
    v_mfma_f32_16x16x32_bf16 v[48:51], v[68:71], v[180:183], v[48:51]
    v_mfma_f32_16x16x32_bf16 v[32:35], v[72:75], v[176:179], v[32:35]
    v_mfma_f32_16x16x32_bf16 v[52:55], v[72:75], v[180:183], v[52:55]
    s_waitcnt vmcnt(12)
    s_waitcnt lgkmcnt(0)
    v_mfma_f32_16x16x32_bf16 v[16:19], v[76:79], v[184:187], v[16:19]
    ds_read_b128 v[56:59], v116 offset:46080
    v_mfma_f32_16x16x32_bf16 v[36:39], v[76:79], v[188:191], v[36:39]
    ds_read_b128 v[60:63], v116 offset:47104
    v_mfma_f32_16x16x32_bf16 v[20:23], v[80:83], v[184:187], v[20:23]
    ds_read_b128 v[64:67], v116 offset:48128
    v_mfma_f32_16x16x32_bf16 v[40:43], v[80:83], v[188:191], v[40:43]
    ds_read_b128 v[68:71], v116 offset:49152
    v_mfma_f32_16x16x32_bf16 v[24:27], v[84:87], v[184:187], v[24:27]
    ds_read_b128 v[72:75], v116 offset:50176
    v_mfma_f32_16x16x32_bf16 v[44:47], v[84:87], v[188:191], v[44:47]
    v_mfma_f32_16x16x32_bf16 v[28:31], v[88:91], v[184:187], v[28:31]
    v_mfma_f32_16x16x32_bf16 v[48:51], v[88:91], v[188:191], v[48:51]
    v_mfma_f32_16x16x32_bf16 v[32:35], v[92:95], v[184:187], v[32:35]
    v_mfma_f32_16x16x32_bf16 v[52:55], v[92:95], v[188:191], v[52:55]
    s_waitcnt vmcnt(10)
    s_waitcnt lgkmcnt(0)
    v_mfma_f32_16x16x32_bf16 v[16:19], v[56:59], v[192:195], v[16:19]
    ds_read_b128 v[76:79], v116 offset:56320
    v_mfma_f32_16x16x32_bf16 v[36:39], v[56:59], v[196:199], v[36:39]
    ds_read_b128 v[80:83], v116 offset:57344
    v_mfma_f32_16x16x32_bf16 v[20:23], v[60:63], v[192:195], v[20:23]
    ds_read_b128 v[84:87], v116 offset:58368
    v_mfma_f32_16x16x32_bf16 v[40:43], v[60:63], v[196:199], v[40:43]
    ds_read_b128 v[88:91], v116 offset:59392
    v_mfma_f32_16x16x32_bf16 v[24:27], v[64:67], v[192:195], v[24:27]
    ds_read_b128 v[92:95], v116 offset:60416
    v_mfma_f32_16x16x32_bf16 v[44:47], v[64:67], v[196:199], v[44:47]
    v_mfma_f32_16x16x32_bf16 v[28:31], v[68:71], v[192:195], v[28:31]
    v_mfma_f32_16x16x32_bf16 v[48:51], v[68:71], v[196:199], v[48:51]
    v_mfma_f32_16x16x32_bf16 v[32:35], v[72:75], v[192:195], v[32:35]
    v_mfma_f32_16x16x32_bf16 v[52:55], v[72:75], v[196:199], v[52:55]
    s_waitcnt vmcnt(8)
    s_waitcnt lgkmcnt(0)
    s_barrier
    v_mfma_f32_16x16x32_bf16 v[16:19], v[76:79], v[200:203], v[16:19]
    ds_read_b128 v[56:59], v118 offset:5120
    v_mfma_f32_16x16x32_bf16 v[36:39], v[76:79], v[204:207], v[36:39]
    ds_read_b128 v[60:63], v118 offset:6144
    v_mfma_f32_16x16x32_bf16 v[20:23], v[80:83], v[200:203], v[20:23]
    ds_read_b128 v[64:67], v118 offset:7168
    v_mfma_f32_16x16x32_bf16 v[40:43], v[80:83], v[204:207], v[40:43]
    ds_read_b128 v[68:71], v118 offset:8192
    v_mfma_f32_16x16x32_bf16 v[24:27], v[84:87], v[200:203], v[24:27]
    ds_read_b128 v[72:75], v118 offset:9216
    v_mfma_f32_16x16x32_bf16 v[44:47], v[84:87], v[204:207], v[44:47]
    v_mfma_f32_16x16x32_bf16 v[28:31], v[88:91], v[200:203], v[28:31]
    v_mfma_f32_16x16x32_bf16 v[48:51], v[88:91], v[204:207], v[48:51]
    v_mfma_f32_16x16x32_bf16 v[32:35], v[92:95], v[200:203], v[32:35]
    v_mfma_f32_16x16x32_bf16 v[52:55], v[92:95], v[204:207], v[52:55]
    s_waitcnt vmcnt(6)
    s_waitcnt lgkmcnt(0)
    v_mfma_f32_16x16x32_bf16 v[16:19], v[56:59], v[208:211], v[16:19]
    ds_read_b128 v[76:79], v118 offset:15360
    v_mfma_f32_16x16x32_bf16 v[36:39], v[56:59], v[212:215], v[36:39]
    ds_read_b128 v[80:83], v118 offset:16384
    v_mfma_f32_16x16x32_bf16 v[20:23], v[60:63], v[208:211], v[20:23]
    ds_read_b128 v[84:87], v118 offset:17408
    v_mfma_f32_16x16x32_bf16 v[40:43], v[60:63], v[212:215], v[40:43]
    ds_read_b128 v[88:91], v118 offset:18432
    v_mfma_f32_16x16x32_bf16 v[24:27], v[64:67], v[208:211], v[24:27]
    ds_read_b128 v[92:95], v118 offset:19456
    v_mfma_f32_16x16x32_bf16 v[44:47], v[64:67], v[212:215], v[44:47]
    v_mfma_f32_16x16x32_bf16 v[28:31], v[68:71], v[208:211], v[28:31]
    v_mfma_f32_16x16x32_bf16 v[48:51], v[68:71], v[212:215], v[48:51]
    v_mfma_f32_16x16x32_bf16 v[32:35], v[72:75], v[208:211], v[32:35]
    v_mfma_f32_16x16x32_bf16 v[52:55], v[72:75], v[212:215], v[52:55]
    s_waitcnt vmcnt(4)
    s_waitcnt lgkmcnt(0)
    v_mfma_f32_16x16x32_bf16 v[16:19], v[76:79], v[216:219], v[16:19]
    ds_read_b128 v[56:59], v117 offset:5120
    v_mfma_f32_16x16x32_bf16 v[36:39], v[76:79], v[220:223], v[36:39]
    ds_read_b128 v[60:63], v117 offset:6144
    v_mfma_f32_16x16x32_bf16 v[20:23], v[80:83], v[216:219], v[20:23]
    ds_read_b128 v[64:67], v117 offset:7168
    v_mfma_f32_16x16x32_bf16 v[40:43], v[80:83], v[220:223], v[40:43]
    ds_read_b128 v[68:71], v117 offset:8192
    v_mfma_f32_16x16x32_bf16 v[24:27], v[84:87], v[216:219], v[24:27]
    ds_read_b128 v[72:75], v117 offset:9216
    v_mfma_f32_16x16x32_bf16 v[44:47], v[84:87], v[220:223], v[44:47]
    v_mfma_f32_16x16x32_bf16 v[28:31], v[88:91], v[216:219], v[28:31]
    v_mfma_f32_16x16x32_bf16 v[48:51], v[88:91], v[220:223], v[48:51]
    v_mfma_f32_16x16x32_bf16 v[32:35], v[92:95], v[216:219], v[32:35]
    v_mfma_f32_16x16x32_bf16 v[52:55], v[92:95], v[220:223], v[52:55]
    s_waitcnt vmcnt(2)
    s_waitcnt lgkmcnt(0)
    v_mfma_f32_16x16x32_bf16 v[16:19], v[56:59], v[224:227], v[16:19]
    ds_read_b128 v[76:79], v117 offset:15360
    v_mfma_f32_16x16x32_bf16 v[36:39], v[56:59], v[228:231], v[36:39]
    ds_read_b128 v[80:83], v117 offset:16384
    v_mfma_f32_16x16x32_bf16 v[20:23], v[60:63], v[224:227], v[20:23]
    ds_read_b128 v[84:87], v117 offset:17408
    v_mfma_f32_16x16x32_bf16 v[40:43], v[60:63], v[228:231], v[40:43]
    ds_read_b128 v[88:91], v117 offset:18432
    v_mfma_f32_16x16x32_bf16 v[24:27], v[64:67], v[224:227], v[24:27]
    ds_read_b128 v[92:95], v117 offset:19456
    v_mfma_f32_16x16x32_bf16 v[44:47], v[64:67], v[228:231], v[44:47]
    v_mfma_f32_16x16x32_bf16 v[28:31], v[68:71], v[224:227], v[28:31]
    v_mfma_f32_16x16x32_bf16 v[48:51], v[68:71], v[228:231], v[48:51]
    v_mfma_f32_16x16x32_bf16 v[32:35], v[72:75], v[224:227], v[32:35]
    v_mfma_f32_16x16x32_bf16 v[52:55], v[72:75], v[228:231], v[52:55]
    s_waitcnt vmcnt(0)
    s_waitcnt lgkmcnt(0)
    v_mfma_f32_16x16x32_bf16 v[16:19], v[76:79], v[232:235], v[16:19]
    v_mfma_f32_16x16x32_bf16 v[36:39], v[76:79], v[236:239], v[36:39]
    v_mfma_f32_16x16x32_bf16 v[20:23], v[80:83], v[232:235], v[20:23]
    v_mfma_f32_16x16x32_bf16 v[40:43], v[80:83], v[236:239], v[40:43]
    v_mfma_f32_16x16x32_bf16 v[24:27], v[84:87], v[232:235], v[24:27]
    v_mfma_f32_16x16x32_bf16 v[44:47], v[84:87], v[236:239], v[44:47]
    v_mfma_f32_16x16x32_bf16 v[28:31], v[88:91], v[232:235], v[28:31]
    v_mfma_f32_16x16x32_bf16 v[48:51], v[88:91], v[236:239], v[48:51]
    v_mfma_f32_16x16x32_bf16 v[32:35], v[92:95], v[232:235], v[32:35]
    v_mfma_f32_16x16x32_bf16 v[52:55], v[92:95], v[236:239], v[52:55]
    s_nop 3
    s_nop 5
    ds_write_b128 v6, v[36:39] offset:0
    ds_write_b128 v6, v[40:43] offset:1024
    ds_write_b128 v6, v[44:47] offset:2048
    ds_write_b128 v6, v[48:51] offset:3072
    ds_write_b128 v6, v[52:55] offset:4096
    s_waitcnt lgkmcnt(0)
    s_barrier
    ds_read_b128 v[36:39], v7 offset:0
    ds_read_b128 v[40:43], v7 offset:1024
    ds_read_b128 v[44:47], v7 offset:2048
    ds_read_b128 v[48:51], v7 offset:3072
    ds_read_b128 v[52:55], v7 offset:4096
    s_waitcnt vmcnt(48)
    v_lshlrev_b32 v96, 16, v96
    v_lshlrev_b32 v97, 16, v97
    v_lshlrev_b32 v98, 16, v98
    v_lshlrev_b32 v99, 16, v99
    v_lshlrev_b32 v100, 16, v100
    v_lshlrev_b32 v101, 16, v101
    v_lshlrev_b32 v102, 16, v102
    v_lshlrev_b32 v103, 16, v103
    v_lshlrev_b32 v104, 16, v104
    v_lshlrev_b32 v105, 16, v105
    v_lshlrev_b32 v106, 16, v106
    v_lshlrev_b32 v107, 16, v107
    v_lshlrev_b32 v108, 16, v108
    v_lshlrev_b32 v109, 16, v109
    v_lshlrev_b32 v110, 16, v110
    v_lshlrev_b32 v111, 16, v111
    v_lshlrev_b32 v112, 16, v112
    v_lshlrev_b32 v113, 16, v113
    v_lshlrev_b32 v114, 16, v114
    v_lshlrev_b32 v115, 16, v115
    s_waitcnt lgkmcnt(0)
    v_pk_add_f32 v[16:17], v[16:17], v[36:37]
    v_cvt_pk_bf16_f32 v16, v16, v17
    v_and_b32 v17, 0xffff0000, v16
    v_lshlrev_b32 v16, 16, v16
    v_pk_add_f32 v[16:17], v[16:17], v[96:97]
    v_cvt_pk_bf16_f32 v56, v16, v17
    v_pk_add_f32 v[18:19], v[18:19], v[38:39]
    v_cvt_pk_bf16_f32 v18, v18, v19
    v_and_b32 v19, 0xffff0000, v18
    v_lshlrev_b32 v18, 16, v18
    v_pk_add_f32 v[18:19], v[18:19], v[98:99]
    v_cvt_pk_bf16_f32 v57, v18, v19
    v_pk_add_f32 v[20:21], v[20:21], v[40:41]
    v_cvt_pk_bf16_f32 v20, v20, v21
    v_and_b32 v21, 0xffff0000, v20
    v_lshlrev_b32 v20, 16, v20
    v_pk_add_f32 v[20:21], v[20:21], v[100:101]
    v_cvt_pk_bf16_f32 v58, v20, v21
    v_pk_add_f32 v[22:23], v[22:23], v[42:43]
    v_cvt_pk_bf16_f32 v22, v22, v23
    v_and_b32 v23, 0xffff0000, v22
    v_lshlrev_b32 v22, 16, v22
    v_pk_add_f32 v[22:23], v[22:23], v[102:103]
    v_cvt_pk_bf16_f32 v59, v22, v23
    buffer_store_dwordx4 v[56:59], v10, s[40:43], s18 offen
    v_pk_add_f32 v[24:25], v[24:25], v[44:45]
    v_cvt_pk_bf16_f32 v24, v24, v25
    v_and_b32 v25, 0xffff0000, v24
    v_lshlrev_b32 v24, 16, v24
    v_pk_add_f32 v[24:25], v[24:25], v[104:105]
    v_cvt_pk_bf16_f32 v60, v24, v25
    v_pk_add_f32 v[26:27], v[26:27], v[46:47]
    v_cvt_pk_bf16_f32 v26, v26, v27
    v_and_b32 v27, 0xffff0000, v26
    v_lshlrev_b32 v26, 16, v26
    v_pk_add_f32 v[26:27], v[26:27], v[106:107]
    v_cvt_pk_bf16_f32 v61, v26, v27
    v_pk_add_f32 v[28:29], v[28:29], v[48:49]
    v_cvt_pk_bf16_f32 v28, v28, v29
    v_and_b32 v29, 0xffff0000, v28
    v_lshlrev_b32 v28, 16, v28
    v_pk_add_f32 v[28:29], v[28:29], v[108:109]
    v_cvt_pk_bf16_f32 v62, v28, v29
    v_pk_add_f32 v[30:31], v[30:31], v[50:51]
    v_cvt_pk_bf16_f32 v30, v30, v31
    v_and_b32 v31, 0xffff0000, v30
    v_lshlrev_b32 v30, 16, v30
    v_pk_add_f32 v[30:31], v[30:31], v[110:111]
    v_cvt_pk_bf16_f32 v63, v30, v31
    buffer_store_dwordx4 v[60:63], v10, s[40:43], s18 offen offset:64
    v_pk_add_f32 v[32:33], v[32:33], v[52:53]
    v_cvt_pk_bf16_f32 v32, v32, v33
    v_and_b32 v33, 0xffff0000, v32
    v_lshlrev_b32 v32, 16, v32
    v_pk_add_f32 v[32:33], v[32:33], v[112:113]
    v_cvt_pk_bf16_f32 v64, v32, v33
    v_pk_add_f32 v[34:35], v[34:35], v[54:55]
    v_cvt_pk_bf16_f32 v34, v34, v35
    v_and_b32 v35, 0xffff0000, v34
    v_lshlrev_b32 v34, 16, v34
    v_pk_add_f32 v[34:35], v[34:35], v[114:115]
    v_cvt_pk_bf16_f32 v65, v34, v35
    buffer_store_dwordx2 v[64:65], v11, s[40:43], s18 offen offset:128
    s_branch L_done
L_done:
L_exit:
    s_endpgm
.fill (32768 - (. - sequential_preLN__ssm_conv_s4d__glu_gated_swiglu__prompt_kernel)) / 4, 4, 0xbf800000
.section .rodata,"a"
.p2align 6
.amdhsa_kernel sequential_preLN__ssm_conv_s4d__glu_gated_swiglu__prompt_kernel
  .amdhsa_next_free_vgpr 244
  .amdhsa_next_free_sgpr 96
  .amdhsa_accum_offset 244
  .amdhsa_group_segment_fixed_size 0
  .amdhsa_kernarg_size 112
  .amdhsa_user_sgpr_count 2
  .amdhsa_user_sgpr_kernarg_segment_ptr 1
  .amdhsa_system_sgpr_workgroup_id_x 1
.end_amdhsa_kernel
```
